```python
import torch

def _softmax(x, axis=-1):
    return torch.softmax(x, dim=axis)
def _gelu(x):
    return torch.nn.functional.gelu(x, approximate="tanh")
def _silu(x):
    return torch.nn.functional.silu(x)
def _sigmoid(x):
    return torch.sigmoid(x)
def _layernorm(x, axis=-1, eps=1e-5):
    m = x.mean(dim=axis, keepdim=True)
    v = x.var(dim=axis, keepdim=True, unbiased=False)
    return (x - m) / torch.sqrt(v + eps)
def _scatter_add(tgt, idx, src, axis=0):
    return tgt.clone().index_add_(axis, idx, src)
def _segment_sum(src, seg, n):
    out = torch.zeros((n,) + src.shape[1:], dtype=src.dtype)
    return out.index_add_(0, seg, src)
def _pad(x, pw):
    flat = tuple(v for pair in reversed(pw) for v in pair)
    return torch.nn.functional.pad(x, flat)

kernel_name = 'sequential_preLN__sliding_block_cached__dense_activation_squared_relu__decode'

def setup_inputs():

    _w = (lambda a: (lambda t: t.to(torch.bfloat16) if t.is_floating_point() else t)(torch.as_tensor(a)))
    def _A_setup():
        B, Sq, D = 1, 1, 512
        Hq, Hkv, Sk, Dh = 32, 32, 32768, 128
        assert Hq % Hkv == 0, (Hq, Hkv)
        return {
            "x": _w((lambda *s: torch.randn(*s, dtype=torch.bfloat16) * 0.05)(B, Sq, D)),
            "k_cache": _w((lambda *s: torch.randn(*s, dtype=torch.bfloat16) * 3.2)(B, Hkv, Sk, Dh)),
            "v_cache": _w((lambda *s: torch.randn(*s, dtype=torch.bfloat16) * 0.4)(B, Hkv, Sk, Dh)),
            "wq": _w((lambda *s: torch.randn(*s, dtype=torch.bfloat16) * 3.2)(D, Hq * Dh) * (D ** -0.5)),
            "wo": _w((lambda *s: torch.randn(*s, dtype=torch.bfloat16) * 0.4)(Hq * Dh, D) * ((Hq * Dh) ** -0.5)),
        }
    _A_in = _A_setup()

    def _B_setup():
        B, S, D, F = 1, 1, 512, 1376
        return {
            "x": _w((lambda *s: torch.randn(*s, dtype=torch.bfloat16) * 0.05)(B, S, D)),
            "w1": _w((lambda *s: torch.randn(*s, dtype=torch.bfloat16) * 0.05)(D, F)),
            "b1": _w((lambda *s: torch.randn(*s, dtype=torch.bfloat16) * 0.8)(F)),
            "w2": _w((lambda *s: torch.randn(*s, dtype=torch.bfloat16) * 0.05)(F, D)),
            "b2": _w((lambda *s: torch.randn(*s, dtype=torch.bfloat16) * 3.2)(D)),
        }
    _B_in = _B_setup()

    return {
        "A_x": _A_in["x"],
        "A_k_cache": _A_in["k_cache"],
        "A_v_cache": _A_in["v_cache"],
        "A_wq": _A_in["wq"],
        "A_wo": _A_in["wo"],
        "B_x": _B_in["x"],
        "B_w1": _B_in["w1"],
        "B_b1": _B_in["b1"],
        "B_w2": _B_in["w2"],
        "B_b2": _B_in["b2"],
    }

def reference(A_x, A_k_cache, A_v_cache, A_wq, A_wo, B_x, B_w1, B_b1, B_w2, B_b2):
    def _A_ref(x, k_cache, v_cache, wq, wo):
        B, Sq, D = x.shape
        Hq, Dh = 32, 128
        Hkv, Sk = k_cache.shape[1], k_cache.shape[2]
        W = min(4096, max(256, Sk // 4))
        rep = Hq // Hkv
        q = (lambda x, *d: x.permute(*d))((x @ wq).reshape(B, Sq, Hq, Dh), 0, 2, 1, 3)
        k = (lambda x, n, axis: torch.repeat_interleave(x, n, dim=axis))(k_cache[:, :, Sk - W:, :], rep, axis=1)
        v = (lambda x, n, axis: torch.repeat_interleave(x, n, dim=axis))(v_cache[:, :, Sk - W:, :], rep, axis=1)
        scores = torch.einsum("bhqd,bhkd->bhqk", q, k) * (Dh ** -0.5)
        p = _softmax(scores, axis=-1)
        o = torch.einsum("bhqk,bhkd->bhqd", p, v)
        return (lambda x, *d: x.permute(*d))(o, 0, 2, 1, 3).reshape(B, Sq, Hq * Dh) @ wo

    def _B_ref(x, w1, b1, w2, b2):
        h = torch.einsum("bsd,df->bsf", x, w1) + b1
        zero = torch.zeros_like(h)
        r = torch.where(h > zero, h, zero)
        h = r * r
        out = torch.einsum("bsf,fd->bsd", h, w2) + b2
        return out

    x = A_x
    h = x + _A_ref(_layernorm(x, axis=-1), A_k_cache, A_v_cache, A_wq, A_wo)
    h2 = h + _B_ref(_layernorm(h, axis=-1), B_w1, B_b1, B_w2, B_b2)
    return h2
```

```asm
; @launch grid=(256,1,1) block=(576,1,1) lds=20480
.amdgcn_target "amdgcn-amd-amdhsa--gfx950"
.text
.globl sequential_preLN__sliding_block_cached__dense_activation_squared_relu__decode_kernel
.p2align 8
.type sequential_preLN__sliding_block_cached__dense_activation_squared_relu__decode_kernel,@function
sequential_preLN__sliding_block_cached__dense_activation_squared_relu__decode_kernel:
    s_load_dwordx8 s[4:11], s[0:1], 0x0
    s_load_dwordx2 s[12:13], s[0:1], 0x20
    s_load_dwordx8 s[16:23], s[0:1], 0x30
    s_load_dwordx4 s[24:27], s[0:1], 0x50
    s_load_dwordx2 s[28:29], s[0:1], 0x60
    s_cmp_ge_u32 s2, 256
    s_cbranch_scc1 L_END
    v_lshrrev_b32 v2, 6, v0
    v_and_b32 v1, 63, v0
    v_readfirstlane_b32 s3, v2
    s_lshr_b32 s30, s2, 3
    s_and_b32 s31, s2, 7
    s_mov_b32 s62, 0xffff0000
    s_mov_b32 s57, 0x3e0293ee
    s_waitcnt lgkmcnt(0)
    s_mov_b32 s32, s6
    s_mov_b32 s33, s7
    s_mov_b32 s34, 0x10000000
    s_mov_b32 s35, 0x00020000
    s_mov_b32 s36, s8
    s_mov_b32 s37, s9
    s_mov_b32 s38, 0x10000000
    s_mov_b32 s39, 0x00020000
    s_mov_b32 s40, s10
    s_mov_b32 s41, s11
    s_mov_b32 s42, 0x400000
    s_mov_b32 s43, 0x00020000
    s_mov_b32 s44, s12
    s_mov_b32 s45, s13
    s_mov_b32 s46, 0x400000
    s_mov_b32 s47, 0x00020000
    s_mov_b32 s48, s16
    s_mov_b32 s49, s17
    s_mov_b32 s50, 0x158000
    s_mov_b32 s51, 0x00020000
    s_mov_b32 s52, s20
    s_mov_b32 s53, s21
    s_mov_b32 s54, 0x158000
    s_mov_b32 s55, 0x00020000
    s_cmp_eq_u32 s3, 8
    s_cbranch_scc1 L_AGENT
    v_lshrrev_b32 v2, 4, v1
    v_and_b32 v3, 15, v1
    s_lshl_b32 s58, s30, 23
    s_lshl_b32 s59, s31, 17
    s_add_u32 s58, s58, s59
    s_lshl_b32 s59, s3, 10
    s_add_u32 s58, s58, s59
    s_add_u32 s58, s58, 0x700000
    v_lshlrev_b32 v5, 4, v1
    v_add_u32 v4, s58, v5
    global_load_dwordx4 v[112:115], v5, s[4:5]
    s_lshl_b32 s58, s31, 7
    s_lshl_b32 s59, s3, 4
    s_add_u32 s58, s58, s59
    v_lshl_add_u32 v6, v2, 2, s58
    global_load_dword v116, v6, s[4:5]
    s_lshl_b32 s58, s31, 19
    s_lshl_b32 s59, s3, 16
    s_add_u32 s58, s58, s59
    s_lshl_b32 s59, s30, 8
    s_add_u32 s58, s58, s59
    v_lshlrev_b32 v6, 14, v2
    v_lshl_add_u32 v6, v3, 4, v6
    v_add_u32 v6, s58, v6
    s_mov_b32 s56, 8192
    buffer_load_dwordx4 v[120:123], v6, s[40:43], 0 offen nt
    buffer_load_dwordx4 v[124:127], v6, s[40:43], s56 offen nt
    v_lshlrev_b32 v6, 1, v0
    global_load_ushort v160, v6, s[4:5]
    s_barrier
    s_mov_b32 s56, 0
    buffer_load_dwordx4 v[48:51], v4, s[32:35], s56 offen nt
    s_mov_b32 s56, 8192
    buffer_load_dwordx4 v[52:55], v4, s[32:35], s56 offen nt
    s_mov_b32 s56, 16384
    buffer_load_dwordx4 v[56:59], v4, s[32:35], s56 offen nt
    s_mov_b32 s56, 24576
    buffer_load_dwordx4 v[60:63], v4, s[32:35], s56 offen nt
    v_and_b32 v7, 1, v2
    v_lshlrev_b32 v7, 1, v7
    v_lshrrev_b32 v36, 1, v2
    v_add_u32 v7, v7, v36
    v_lshl_add_u32 v7, v3, 3, v7
    v_lshlrev_b32 v7, 2, v7
    s_lshl_b32 s58, s3, 9
    v_add_u32 v7, s58, v7
    s_waitcnt vmcnt(5)
    s_mov_b32 s56, 32768
    buffer_load_dwordx4 v[64:67], v4, s[32:35], s56 offen nt
    s_mov_b32 s56, 40960
    buffer_load_dwordx4 v[68:71], v4, s[32:35], s56 offen nt
    s_mov_b32 s56, 49152
    buffer_load_dwordx4 v[72:75], v4, s[32:35], s56 offen nt
    s_mov_b32 s56, 57344
    buffer_load_dwordx4 v[76:79], v4, s[32:35], s56 offen nt
    v_lshlrev_b32 v36, 16, v112
    v_and_b32 v37, s62, v112
    v_lshlrev_b32 v38, 16, v113
    v_and_b32 v39, s62, v113
    v_lshlrev_b32 v40, 16, v114
    v_and_b32 v41, s62, v114
    v_lshlrev_b32 v42, 16, v115
    v_and_b32 v43, s62, v115
    v_add_f32 v44, v36, v37
    v_add_f32 v45, v38, v39
    v_add_f32 v46, v40, v41
    v_add_f32 v47, v42, v43
    v_add_f32 v44, v44, v45
    v_add_f32 v46, v46, v47
    v_add_f32 v44, v44, v46
    s_nop 1
    v_add_f32 v44, v44, v44 row_ror:8 row_mask:0xf bank_mask:0xf
    s_nop 1
    v_add_f32 v44, v44, v44 row_ror:4 row_mask:0xf bank_mask:0xf
    s_nop 1
    v_add_f32 v44, v44, v44 row_ror:2 row_mask:0xf bank_mask:0xf
    s_nop 1
    v_add_f32 v44, v44, v44 row_ror:1 row_mask:0xf bank_mask:0xf
    v_mov_b32 v45, v44
    s_nop 1
    v_permlane32_swap_b32 v44, v45
    v_add_f32 v44, v44, v45
    v_mov_b32 v45, v44
    s_nop 1
    v_permlane16_swap_b32 v44, v45
    v_add_f32 v44, v44, v45
    v_mul_f32 v44, 0x3b000000, v44
    v_sub_f32 v36, v36, v44
    v_sub_f32 v37, v37, v44
    v_sub_f32 v38, v38, v44
    v_sub_f32 v39, v39, v44
    v_sub_f32 v40, v40, v44
    v_sub_f32 v41, v41, v44
    v_sub_f32 v42, v42, v44
    v_sub_f32 v43, v43, v44
    v_mul_f32 v45, v36, v36
    v_fmac_f32 v45, v37, v37
    v_fmac_f32 v45, v38, v38
    v_fmac_f32 v45, v39, v39
    v_fmac_f32 v45, v40, v40
    v_fmac_f32 v45, v41, v41
    v_fmac_f32 v45, v42, v42
    v_fmac_f32 v45, v43, v43
    s_nop 1
    v_add_f32 v45, v45, v45 row_ror:8 row_mask:0xf bank_mask:0xf
    s_nop 1
    v_add_f32 v45, v45, v45 row_ror:4 row_mask:0xf bank_mask:0xf
    s_nop 1
    v_add_f32 v45, v45, v45 row_ror:2 row_mask:0xf bank_mask:0xf
    s_nop 1
    v_add_f32 v45, v45, v45 row_ror:1 row_mask:0xf bank_mask:0xf
    v_mov_b32 v46, v45
    s_nop 1
    v_permlane32_swap_b32 v45, v46
    v_add_f32 v45, v45, v46
    v_mov_b32 v46, v45
    s_nop 1
    v_permlane16_swap_b32 v45, v46
    v_add_f32 v45, v45, v46
    v_mul_f32 v45, 0x3b000000, v45
    v_add_f32 v45, 0x3727c5ac, v45
    v_rsq_f32 v45, v45
    v_lshlrev_b32 v117, 16, v116
    v_and_b32 v118, s62, v116
    v_sub_f32 v117, v117, v44
    v_sub_f32 v118, v118, v44
    v_mul_f32 v117, v117, v45
    v_mul_f32 v118, v118, v45
    v_lshlrev_b32 v36, 16, v120
    v_and_b32 v37, s62, v120
    v_lshlrev_b32 v38, 16, v124
    v_and_b32 v39, s62, v124
    v_mul_f32 v12, v117, v36
    v_mul_f32 v13, v117, v37
    v_fmac_f32 v12, v118, v38
    v_fmac_f32 v13, v118, v39
    v_lshlrev_b32 v36, 16, v121
    v_and_b32 v37, s62, v121
    v_lshlrev_b32 v38, 16, v125
    v_and_b32 v39, s62, v125
    v_mul_f32 v14, v117, v36
    v_mul_f32 v15, v117, v37
    v_fmac_f32 v14, v118, v38
    v_fmac_f32 v15, v118, v39
    v_lshlrev_b32 v36, 16, v122
    v_and_b32 v37, s62, v122
    v_lshlrev_b32 v38, 16, v126
    v_and_b32 v39, s62, v126
    v_mul_f32 v16, v117, v36
    v_mul_f32 v17, v117, v37
    v_fmac_f32 v16, v118, v38
    v_fmac_f32 v17, v118, v39
    v_lshlrev_b32 v36, 16, v123
    v_and_b32 v37, s62, v123
    v_lshlrev_b32 v38, 16, v127
    v_and_b32 v39, s62, v127
    v_mul_f32 v18, v117, v36
    v_mul_f32 v19, v117, v37
    v_fmac_f32 v18, v118, v38
    v_fmac_f32 v19, v118, v39
    v_permlane32_swap_b32 v12, v13
    v_permlane32_swap_b32 v14, v15
    v_permlane32_swap_b32 v16, v17
    v_permlane32_swap_b32 v18, v19
    v_add_f32 v12, v12, v13
    v_add_f32 v14, v14, v15
    v_add_f32 v16, v16, v17
    v_add_f32 v18, v18, v19
    v_permlane16_swap_b32 v12, v14
    s_nop 0
    v_permlane16_swap_b32 v16, v18
    v_add_f32 v12, v12, v14
    v_add_f32 v16, v16, v18
    ds_write2_b32 v7, v12, v16 offset0:0 offset1:4
    s_waitcnt lgkmcnt(0)
    v_mov_b32 v36, 1
    v_mov_b32 v37, 0
    s_mov_b64 exec, 1
    ds_add_u32 v37, v36 offset:4680
    s_mov_b64 exec, -1
    s_waitcnt vmcnt(3)
    s_mov_b32 s56, 65536
    buffer_load_dwordx4 v[80:83], v4, s[32:35], s56 offen nt
    s_waitcnt vmcnt(3)
    s_mov_b32 s56, 73728
    buffer_load_dwordx4 v[84:87], v4, s[32:35], s56 offen nt
    s_waitcnt vmcnt(3)
    s_mov_b32 s56, 81920
    buffer_load_dwordx4 v[88:91], v4, s[32:35], s56 offen nt
    s_waitcnt vmcnt(3)
    s_mov_b32 s56, 90112
    buffer_load_dwordx4 v[92:95], v4, s[32:35], s56 offen nt
    s_waitcnt vmcnt(3)
    s_mov_b32 s56, 98304
    buffer_load_dwordx4 v[96:99], v4, s[32:35], s56 offen nt
    s_waitcnt vmcnt(3)
    s_mov_b32 s56, 106496
    buffer_load_dwordx4 v[100:103], v4, s[32:35], s56 offen nt
    s_waitcnt vmcnt(3)
    s_mov_b32 s56, 114688
    buffer_load_dwordx4 v[104:107], v4, s[32:35], s56 offen nt
    s_waitcnt vmcnt(3)
    s_mov_b32 s56, 122880
    buffer_load_dwordx4 v[108:111], v4, s[32:35], s56 offen nt
    s_waitcnt vmcnt(3)
    s_mov_b32 s56, 0
    buffer_load_dwordx4 v[112:115], v4, s[36:39], s56 offen nt
    s_waitcnt vmcnt(3)
    s_mov_b32 s56, 8192
    buffer_load_dwordx4 v[116:119], v4, s[36:39], s56 offen nt
    s_waitcnt vmcnt(3)
    s_mov_b32 s56, 16384
    buffer_load_dwordx4 v[120:123], v4, s[36:39], s56 offen nt
    s_waitcnt vmcnt(3)
    s_mov_b32 s56, 24576
    buffer_load_dwordx4 v[124:127], v4, s[36:39], s56 offen nt
    s_waitcnt vmcnt(3)
    s_mov_b32 s56, 32768
    buffer_load_dwordx4 v[128:131], v4, s[36:39], s56 offen nt
    s_waitcnt vmcnt(3)
    s_mov_b32 s56, 40960
    buffer_load_dwordx4 v[132:135], v4, s[36:39], s56 offen nt
    s_waitcnt vmcnt(3)
    s_mov_b32 s56, 49152
    buffer_load_dwordx4 v[136:139], v4, s[36:39], s56 offen nt
    s_waitcnt vmcnt(3)
    s_mov_b32 s56, 57344
    buffer_load_dwordx4 v[140:143], v4, s[36:39], s56 offen nt
    v_mov_b32 v37, 0
    s_mov_b32 s63, 0
L_QW:
    ds_read_b32 v36, v37 offset:4684
    s_waitcnt lgkmcnt(0)
    v_readfirstlane_b32 s58, v36
    s_nop 0
    s_cmp_eq_u32 s58, 0
    s_cbranch_scc0 L_QW_done
    s_add_u32 s63, s63, 1
    s_cmp_lt_u32 s63, 3200000
    s_cbranch_scc1 L_QW
L_QW_done:
    v_lshlrev_b32 v36, 4, v3
    ds_read_b128 v[8:11], v36 offset:4096
    s_waitcnt lgkmcnt(0)
    v_dot2_f32_bf16 v20, v48, v8, 0
    v_dot2_f32_bf16 v21, v52, v8, 0
    v_dot2_f32_bf16 v22, v56, v8, 0
    v_dot2_f32_bf16 v23, v60, v8, 0
    v_dot2_f32_bf16 v20, v49, v9, v20
    v_dot2_f32_bf16 v21, v53, v9, v21
    v_dot2_f32_bf16 v22, v57, v9, v22
    v_dot2_f32_bf16 v23, v61, v9, v23
    v_dot2_f32_bf16 v20, v50, v10, v20
    v_dot2_f32_bf16 v21, v54, v10, v21
    v_dot2_f32_bf16 v22, v58, v10, v22
    v_dot2_f32_bf16 v23, v62, v10, v23
    v_dot2_f32_bf16 v20, v51, v11, v20
    v_dot2_f32_bf16 v21, v55, v11, v21
    v_dot2_f32_bf16 v22, v59, v11, v22
    v_dot2_f32_bf16 v23, v63, v11, v23
    s_mov_b32 s56, 65536
    buffer_load_dwordx4 v[48:51], v4, s[36:39], s56 offen nt
    s_mov_b32 s56, 73728
    buffer_load_dwordx4 v[52:55], v4, s[36:39], s56 offen nt
    s_mov_b32 s56, 81920
    buffer_load_dwordx4 v[56:59], v4, s[36:39], s56 offen nt
    s_mov_b32 s56, 90112
    buffer_load_dwordx4 v[60:63], v4, s[36:39], s56 offen nt
    v_add_f32 v20, v20, v20 row_ror:8 row_mask:0xf bank_mask:0xf
    v_add_f32 v21, v21, v21 row_ror:8 row_mask:0xf bank_mask:0xf
    v_add_f32 v22, v22, v22 row_ror:8 row_mask:0xf bank_mask:0xf
    v_add_f32 v23, v23, v23 row_ror:8 row_mask:0xf bank_mask:0xf
    v_add_f32 v20, v20, v20 row_ror:4 row_mask:0xf bank_mask:0xf
    v_add_f32 v21, v21, v21 row_ror:4 row_mask:0xf bank_mask:0xf
    v_add_f32 v22, v22, v22 row_ror:4 row_mask:0xf bank_mask:0xf
    v_add_f32 v23, v23, v23 row_ror:4 row_mask:0xf bank_mask:0xf
    v_add_f32 v20, v20, v20 row_ror:2 row_mask:0xf bank_mask:0xf
    v_add_f32 v21, v21, v21 row_ror:2 row_mask:0xf bank_mask:0xf
    v_add_f32 v22, v22, v22 row_ror:2 row_mask:0xf bank_mask:0xf
    v_add_f32 v23, v23, v23 row_ror:2 row_mask:0xf bank_mask:0xf
    v_add_f32 v20, v20, v20 row_ror:1 row_mask:0xf bank_mask:0xf
    v_add_f32 v21, v21, v21 row_ror:1 row_mask:0xf bank_mask:0xf
    v_add_f32 v22, v22, v22 row_ror:1 row_mask:0xf bank_mask:0xf
    v_add_f32 v23, v23, v23 row_ror:1 row_mask:0xf bank_mask:0xf
    v_dot2_f32_bf16 v24, v64, v8, 0
    v_dot2_f32_bf16 v25, v68, v8, 0
    v_dot2_f32_bf16 v26, v72, v8, 0
    v_dot2_f32_bf16 v27, v76, v8, 0
    v_dot2_f32_bf16 v24, v65, v9, v24
    v_dot2_f32_bf16 v25, v69, v9, v25
    v_dot2_f32_bf16 v26, v73, v9, v26
    v_dot2_f32_bf16 v27, v77, v9, v27
    v_dot2_f32_bf16 v24, v66, v10, v24
    v_dot2_f32_bf16 v25, v70, v10, v25
    v_dot2_f32_bf16 v26, v74, v10, v26
    v_dot2_f32_bf16 v27, v78, v10, v27
    v_dot2_f32_bf16 v24, v67, v11, v24
    v_dot2_f32_bf16 v25, v71, v11, v25
    v_dot2_f32_bf16 v26, v75, v11, v26
    v_dot2_f32_bf16 v27, v79, v11, v27
    s_mov_b32 s56, 98304
    buffer_load_dwordx4 v[64:67], v4, s[36:39], s56 offen nt
    s_mov_b32 s56, 106496
    buffer_load_dwordx4 v[68:71], v4, s[36:39], s56 offen nt
    s_mov_b32 s56, 114688
    buffer_load_dwordx4 v[72:75], v4, s[36:39], s56 offen nt
    s_mov_b32 s56, 122880
    buffer_load_dwordx4 v[76:79], v4, s[36:39], s56 offen nt
    v_add_f32 v24, v24, v24 row_ror:8 row_mask:0xf bank_mask:0xf
    v_add_f32 v25, v25, v25 row_ror:8 row_mask:0xf bank_mask:0xf
    v_add_f32 v26, v26, v26 row_ror:8 row_mask:0xf bank_mask:0xf
    v_add_f32 v27, v27, v27 row_ror:8 row_mask:0xf bank_mask:0xf
    v_add_f32 v24, v24, v24 row_ror:4 row_mask:0xf bank_mask:0xf
    v_add_f32 v25, v25, v25 row_ror:4 row_mask:0xf bank_mask:0xf
    v_add_f32 v26, v26, v26 row_ror:4 row_mask:0xf bank_mask:0xf
    v_add_f32 v27, v27, v27 row_ror:4 row_mask:0xf bank_mask:0xf
    v_add_f32 v24, v24, v24 row_ror:2 row_mask:0xf bank_mask:0xf
    v_add_f32 v25, v25, v25 row_ror:2 row_mask:0xf bank_mask:0xf
    v_add_f32 v26, v26, v26 row_ror:2 row_mask:0xf bank_mask:0xf
    v_add_f32 v27, v27, v27 row_ror:2 row_mask:0xf bank_mask:0xf
    v_add_f32 v24, v24, v24 row_ror:1 row_mask:0xf bank_mask:0xf
    v_add_f32 v25, v25, v25 row_ror:1 row_mask:0xf bank_mask:0xf
    v_add_f32 v26, v26, v26 row_ror:1 row_mask:0xf bank_mask:0xf
    v_add_f32 v27, v27, v27 row_ror:1 row_mask:0xf bank_mask:0xf
    v_dot2_f32_bf16 v28, v80, v8, 0
    v_dot2_f32_bf16 v29, v84, v8, 0
    v_dot2_f32_bf16 v30, v88, v8, 0
    v_dot2_f32_bf16 v31, v92, v8, 0
    v_dot2_f32_bf16 v28, v81, v9, v28
    v_dot2_f32_bf16 v29, v85, v9, v29
    v_dot2_f32_bf16 v30, v89, v9, v30
    v_dot2_f32_bf16 v31, v93, v9, v31
    v_dot2_f32_bf16 v28, v82, v10, v28
    v_dot2_f32_bf16 v29, v86, v10, v29
    v_dot2_f32_bf16 v30, v90, v10, v30
    v_dot2_f32_bf16 v31, v94, v10, v31
    v_dot2_f32_bf16 v28, v83, v11, v28
    v_dot2_f32_bf16 v29, v87, v11, v29
    v_dot2_f32_bf16 v30, v91, v11, v30
    v_dot2_f32_bf16 v31, v95, v11, v31
    v_add_f32 v28, v28, v28 row_ror:8 row_mask:0xf bank_mask:0xf
    v_add_f32 v29, v29, v29 row_ror:8 row_mask:0xf bank_mask:0xf
    v_add_f32 v30, v30, v30 row_ror:8 row_mask:0xf bank_mask:0xf
    v_add_f32 v31, v31, v31 row_ror:8 row_mask:0xf bank_mask:0xf
    v_add_f32 v28, v28, v28 row_ror:4 row_mask:0xf bank_mask:0xf
    v_add_f32 v29, v29, v29 row_ror:4 row_mask:0xf bank_mask:0xf
    v_add_f32 v30, v30, v30 row_ror:4 row_mask:0xf bank_mask:0xf
    v_add_f32 v31, v31, v31 row_ror:4 row_mask:0xf bank_mask:0xf
    v_add_f32 v28, v28, v28 row_ror:2 row_mask:0xf bank_mask:0xf
    v_add_f32 v29, v29, v29 row_ror:2 row_mask:0xf bank_mask:0xf
    v_add_f32 v30, v30, v30 row_ror:2 row_mask:0xf bank_mask:0xf
    v_add_f32 v31, v31, v31 row_ror:2 row_mask:0xf bank_mask:0xf
    v_add_f32 v28, v28, v28 row_ror:1 row_mask:0xf bank_mask:0xf
    v_add_f32 v29, v29, v29 row_ror:1 row_mask:0xf bank_mask:0xf
    v_add_f32 v30, v30, v30 row_ror:1 row_mask:0xf bank_mask:0xf
    v_add_f32 v31, v31, v31 row_ror:1 row_mask:0xf bank_mask:0xf
    v_dot2_f32_bf16 v32, v96, v8, 0
    v_dot2_f32_bf16 v33, v100, v8, 0
    v_dot2_f32_bf16 v34, v104, v8, 0
    v_dot2_f32_bf16 v35, v108, v8, 0
    v_dot2_f32_bf16 v32, v97, v9, v32
    v_dot2_f32_bf16 v33, v101, v9, v33
    v_dot2_f32_bf16 v34, v105, v9, v34
    v_dot2_f32_bf16 v35, v109, v9, v35
    v_dot2_f32_bf16 v32, v98, v10, v32
    v_dot2_f32_bf16 v33, v102, v10, v33
    v_dot2_f32_bf16 v34, v106, v10, v34
    v_dot2_f32_bf16 v35, v110, v10, v35
    v_dot2_f32_bf16 v32, v99, v11, v32
    v_dot2_f32_bf16 v33, v103, v11, v33
    v_dot2_f32_bf16 v34, v107, v11, v34
    v_dot2_f32_bf16 v35, v111, v11, v35
    v_add_f32 v32, v32, v32 row_ror:8 row_mask:0xf bank_mask:0xf
    v_add_f32 v33, v33, v33 row_ror:8 row_mask:0xf bank_mask:0xf
    v_add_f32 v34, v34, v34 row_ror:8 row_mask:0xf bank_mask:0xf
    v_add_f32 v35, v35, v35 row_ror:8 row_mask:0xf bank_mask:0xf
    v_add_f32 v32, v32, v32 row_ror:4 row_mask:0xf bank_mask:0xf
    v_add_f32 v33, v33, v33 row_ror:4 row_mask:0xf bank_mask:0xf
    v_add_f32 v34, v34, v34 row_ror:4 row_mask:0xf bank_mask:0xf
    v_add_f32 v35, v35, v35 row_ror:4 row_mask:0xf bank_mask:0xf
    v_add_f32 v32, v32, v32 row_ror:2 row_mask:0xf bank_mask:0xf
    v_add_f32 v33, v33, v33 row_ror:2 row_mask:0xf bank_mask:0xf
    v_add_f32 v34, v34, v34 row_ror:2 row_mask:0xf bank_mask:0xf
    v_add_f32 v35, v35, v35 row_ror:2 row_mask:0xf bank_mask:0xf
    v_add_f32 v32, v32, v32 row_ror:1 row_mask:0xf bank_mask:0xf
    v_add_f32 v33, v33, v33 row_ror:1 row_mask:0xf bank_mask:0xf
    v_add_f32 v34, v34, v34 row_ror:1 row_mask:0xf bank_mask:0xf
    v_add_f32 v35, v35, v35 row_ror:1 row_mask:0xf bank_mask:0xf
    v_max3_f32 v36, v20, v21, v22
    v_max3_f32 v36, v36, v23, v24
    v_max3_f32 v36, v36, v25, v26
    v_max3_f32 v36, v36, v27, v28
    v_max3_f32 v36, v36, v29, v30
    v_max3_f32 v36, v36, v31, v32
    v_max3_f32 v36, v36, v33, v34
    v_max_f32 v36, v36, v35
    v_mov_b32 v37, v36
    s_nop 1
    v_permlane32_swap_b32 v36, v37
    v_max_f32 v36, v36, v37
    v_mov_b32 v37, v36
    s_nop 1
    v_permlane16_swap_b32 v36, v37
    v_max_f32 v36, v36, v37
    v_mul_f32 v37, s57, v36
    v_fma_f32 v20, v20, s57, -v37
    v_fma_f32 v21, v21, s57, -v37
    v_fma_f32 v22, v22, s57, -v37
    v_fma_f32 v23, v23, s57, -v37
    v_fma_f32 v24, v24, s57, -v37
    v_fma_f32 v25, v25, s57, -v37
    v_fma_f32 v26, v26, s57, -v37
    v_fma_f32 v27, v27, s57, -v37
    v_fma_f32 v28, v28, s57, -v37
    v_fma_f32 v29, v29, s57, -v37
    v_fma_f32 v30, v30, s57, -v37
    v_fma_f32 v31, v31, s57, -v37
    v_fma_f32 v32, v32, s57, -v37
    v_fma_f32 v33, v33, s57, -v37
    v_fma_f32 v34, v34, s57, -v37
    v_fma_f32 v35, v35, s57, -v37
    v_exp_f32 v20, v20
    v_exp_f32 v21, v21
    v_exp_f32 v22, v22
    v_exp_f32 v23, v23
    v_exp_f32 v24, v24
    v_exp_f32 v25, v25
    v_exp_f32 v26, v26
    v_exp_f32 v27, v27
    v_exp_f32 v28, v28
    v_exp_f32 v29, v29
    v_exp_f32 v30, v30
    v_exp_f32 v31, v31
    v_exp_f32 v32, v32
    v_exp_f32 v33, v33
    v_exp_f32 v34, v34
    v_exp_f32 v35, v35
    v_add_f32 v37, v20, v21
    v_add_f32 v37, v37, v22
    v_add_f32 v37, v37, v23
    v_add_f32 v37, v37, v24
    v_add_f32 v37, v37, v25
    v_add_f32 v37, v37, v26
    v_add_f32 v37, v37, v27
    v_add_f32 v37, v37, v28
    v_add_f32 v37, v37, v29
    v_add_f32 v37, v37, v30
    v_add_f32 v37, v37, v31
    v_add_f32 v37, v37, v32
    v_add_f32 v37, v37, v33
    v_add_f32 v37, v37, v34
    v_add_f32 v37, v37, v35
    v_lshlrev_b32 v40, 16, v112
    v_and_b32 v41, s62, v112
    v_mul_f32 v12, v20, v40
    v_mul_f32 v13, v20, v41
    v_lshlrev_b32 v40, 16, v113
    v_and_b32 v41, s62, v113
    v_mul_f32 v14, v20, v40
    v_mul_f32 v15, v20, v41
    v_lshlrev_b32 v40, 16, v114
    v_and_b32 v41, s62, v114
    v_mul_f32 v16, v20, v40
    v_mul_f32 v17, v20, v41
    v_lshlrev_b32 v40, 16, v115
    v_and_b32 v41, s62, v115
    v_mul_f32 v18, v20, v40
    v_mul_f32 v19, v20, v41
    v_lshlrev_b32 v40, 16, v116
    v_and_b32 v41, s62, v116
    v_fmac_f32 v12, v21, v40
    v_fmac_f32 v13, v21, v41
    v_lshlrev_b32 v40, 16, v117
    v_and_b32 v41, s62, v117
    v_fmac_f32 v14, v21, v40
    v_fmac_f32 v15, v21, v41
    v_lshlrev_b32 v40, 16, v118
    v_and_b32 v41, s62, v118
    v_fmac_f32 v16, v21, v40
    v_fmac_f32 v17, v21, v41
    v_lshlrev_b32 v40, 16, v119
    v_and_b32 v41, s62, v119
    v_fmac_f32 v18, v21, v40
    v_fmac_f32 v19, v21, v41
    v_lshlrev_b32 v40, 16, v120
    v_and_b32 v41, s62, v120
    v_fmac_f32 v12, v22, v40
    v_fmac_f32 v13, v22, v41
    v_lshlrev_b32 v40, 16, v121
    v_and_b32 v41, s62, v121
    v_fmac_f32 v14, v22, v40
    v_fmac_f32 v15, v22, v41
    v_lshlrev_b32 v40, 16, v122
    v_and_b32 v41, s62, v122
    v_fmac_f32 v16, v22, v40
    v_fmac_f32 v17, v22, v41
    v_lshlrev_b32 v40, 16, v123
    v_and_b32 v41, s62, v123
    v_fmac_f32 v18, v22, v40
    v_fmac_f32 v19, v22, v41
    v_lshlrev_b32 v40, 16, v124
    v_and_b32 v41, s62, v124
    v_fmac_f32 v12, v23, v40
    v_fmac_f32 v13, v23, v41
    v_lshlrev_b32 v40, 16, v125
    v_and_b32 v41, s62, v125
    v_fmac_f32 v14, v23, v40
    v_fmac_f32 v15, v23, v41
    v_lshlrev_b32 v40, 16, v126
    v_and_b32 v41, s62, v126
    v_fmac_f32 v16, v23, v40
    v_fmac_f32 v17, v23, v41
    v_lshlrev_b32 v40, 16, v127
    v_and_b32 v41, s62, v127
    v_fmac_f32 v18, v23, v40
    v_fmac_f32 v19, v23, v41
    s_waitcnt vmcnt(11)
    v_lshlrev_b32 v40, 16, v128
    v_and_b32 v41, s62, v128
    v_fmac_f32 v12, v24, v40
    v_fmac_f32 v13, v24, v41
    v_lshlrev_b32 v40, 16, v129
    v_and_b32 v41, s62, v129
    v_fmac_f32 v14, v24, v40
    v_fmac_f32 v15, v24, v41
    v_lshlrev_b32 v40, 16, v130
    v_and_b32 v41, s62, v130
    v_fmac_f32 v16, v24, v40
    v_fmac_f32 v17, v24, v41
    v_lshlrev_b32 v40, 16, v131
    v_and_b32 v41, s62, v131
    v_fmac_f32 v18, v24, v40
    v_fmac_f32 v19, v24, v41
    s_waitcnt vmcnt(10)
    v_lshlrev_b32 v40, 16, v132
    v_and_b32 v41, s62, v132
    v_fmac_f32 v12, v25, v40
    v_fmac_f32 v13, v25, v41
    v_lshlrev_b32 v40, 16, v133
    v_and_b32 v41, s62, v133
    v_fmac_f32 v14, v25, v40
    v_fmac_f32 v15, v25, v41
    v_lshlrev_b32 v40, 16, v134
    v_and_b32 v41, s62, v134
    v_fmac_f32 v16, v25, v40
    v_fmac_f32 v17, v25, v41
    v_lshlrev_b32 v40, 16, v135
    v_and_b32 v41, s62, v135
    v_fmac_f32 v18, v25, v40
    v_fmac_f32 v19, v25, v41
    s_waitcnt vmcnt(9)
    v_lshlrev_b32 v40, 16, v136
    v_and_b32 v41, s62, v136
    v_fmac_f32 v12, v26, v40
    v_fmac_f32 v13, v26, v41
    v_lshlrev_b32 v40, 16, v137
    v_and_b32 v41, s62, v137
    v_fmac_f32 v14, v26, v40
    v_fmac_f32 v15, v26, v41
    v_lshlrev_b32 v40, 16, v138
    v_and_b32 v41, s62, v138
    v_fmac_f32 v16, v26, v40
    v_fmac_f32 v17, v26, v41
    v_lshlrev_b32 v40, 16, v139
    v_and_b32 v41, s62, v139
    v_fmac_f32 v18, v26, v40
    v_fmac_f32 v19, v26, v41
    v_mov_b32 v40, 1
    v_mov_b32 v41, 0
    s_mov_b64 exec, 1
    ds_add_u32 v41, v40 offset:4688
    s_mov_b64 exec, -1
    s_waitcnt vmcnt(8)
    v_lshlrev_b32 v40, 16, v140
    v_and_b32 v41, s62, v140
    v_fmac_f32 v12, v27, v40
    v_fmac_f32 v13, v27, v41
    v_lshlrev_b32 v40, 16, v141
    v_and_b32 v41, s62, v141
    v_fmac_f32 v14, v27, v40
    v_fmac_f32 v15, v27, v41
    v_lshlrev_b32 v40, 16, v142
    v_and_b32 v41, s62, v142
    v_fmac_f32 v16, v27, v40
    v_fmac_f32 v17, v27, v41
    v_lshlrev_b32 v40, 16, v143
    v_and_b32 v41, s62, v143
    v_fmac_f32 v18, v27, v40
    v_fmac_f32 v19, v27, v41
    s_waitcnt vmcnt(7)
    v_lshlrev_b32 v40, 16, v48
    v_and_b32 v41, s62, v48
    v_fmac_f32 v12, v28, v40
    v_fmac_f32 v13, v28, v41
    v_lshlrev_b32 v40, 16, v49
    v_and_b32 v41, s62, v49
    v_fmac_f32 v14, v28, v40
    v_fmac_f32 v15, v28, v41
    v_lshlrev_b32 v40, 16, v50
    v_and_b32 v41, s62, v50
    v_fmac_f32 v16, v28, v40
    v_fmac_f32 v17, v28, v41
    v_lshlrev_b32 v40, 16, v51
    v_and_b32 v41, s62, v51
    v_fmac_f32 v18, v28, v40
    v_fmac_f32 v19, v28, v41
    s_waitcnt vmcnt(6)
    v_lshlrev_b32 v40, 16, v52
    v_and_b32 v41, s62, v52
    v_fmac_f32 v12, v29, v40
    v_fmac_f32 v13, v29, v41
    v_lshlrev_b32 v40, 16, v53
    v_and_b32 v41, s62, v53
    v_fmac_f32 v14, v29, v40
    v_fmac_f32 v15, v29, v41
    v_lshlrev_b32 v40, 16, v54
    v_and_b32 v41, s62, v54
    v_fmac_f32 v16, v29, v40
    v_fmac_f32 v17, v29, v41
    v_lshlrev_b32 v40, 16, v55
    v_and_b32 v41, s62, v55
    v_fmac_f32 v18, v29, v40
    v_fmac_f32 v19, v29, v41
    s_waitcnt vmcnt(5)
    v_lshlrev_b32 v40, 16, v56
    v_and_b32 v41, s62, v56
    v_fmac_f32 v12, v30, v40
    v_fmac_f32 v13, v30, v41
    v_lshlrev_b32 v40, 16, v57
    v_and_b32 v41, s62, v57
    v_fmac_f32 v14, v30, v40
    v_fmac_f32 v15, v30, v41
    v_lshlrev_b32 v40, 16, v58
    v_and_b32 v41, s62, v58
    v_fmac_f32 v16, v30, v40
    v_fmac_f32 v17, v30, v41
    v_lshlrev_b32 v40, 16, v59
    v_and_b32 v41, s62, v59
    v_fmac_f32 v18, v30, v40
    v_fmac_f32 v19, v30, v41
    s_waitcnt vmcnt(4)
    v_lshlrev_b32 v40, 16, v60
    v_and_b32 v41, s62, v60
    v_fmac_f32 v12, v31, v40
    v_fmac_f32 v13, v31, v41
    v_lshlrev_b32 v40, 16, v61
    v_and_b32 v41, s62, v61
    v_fmac_f32 v14, v31, v40
    v_fmac_f32 v15, v31, v41
    v_lshlrev_b32 v40, 16, v62
    v_and_b32 v41, s62, v62
    v_fmac_f32 v16, v31, v40
    v_fmac_f32 v17, v31, v41
    v_lshlrev_b32 v40, 16, v63
    v_and_b32 v41, s62, v63
    v_fmac_f32 v18, v31, v40
    v_fmac_f32 v19, v31, v41
    s_waitcnt vmcnt(3)
    v_lshlrev_b32 v40, 16, v64
    v_and_b32 v41, s62, v64
    v_fmac_f32 v12, v32, v40
    v_fmac_f32 v13, v32, v41
    v_lshlrev_b32 v40, 16, v65
    v_and_b32 v41, s62, v65
    v_fmac_f32 v14, v32, v40
    v_fmac_f32 v15, v32, v41
    v_lshlrev_b32 v40, 16, v66
    v_and_b32 v41, s62, v66
    v_fmac_f32 v16, v32, v40
    v_fmac_f32 v17, v32, v41
    v_lshlrev_b32 v40, 16, v67
    v_and_b32 v41, s62, v67
    v_fmac_f32 v18, v32, v40
    v_fmac_f32 v19, v32, v41
    s_waitcnt vmcnt(2)
    v_lshlrev_b32 v40, 16, v68
    v_and_b32 v41, s62, v68
    v_fmac_f32 v12, v33, v40
    v_fmac_f32 v13, v33, v41
    v_lshlrev_b32 v40, 16, v69
    v_and_b32 v41, s62, v69
    v_fmac_f32 v14, v33, v40
    v_fmac_f32 v15, v33, v41
    v_lshlrev_b32 v40, 16, v70
    v_and_b32 v41, s62, v70
    v_fmac_f32 v16, v33, v40
    v_fmac_f32 v17, v33, v41
    v_lshlrev_b32 v40, 16, v71
    v_and_b32 v41, s62, v71
    v_fmac_f32 v18, v33, v40
    v_fmac_f32 v19, v33, v41
    s_waitcnt vmcnt(1)
    v_lshlrev_b32 v40, 16, v72
    v_and_b32 v41, s62, v72
    v_fmac_f32 v12, v34, v40
    v_fmac_f32 v13, v34, v41
    v_lshlrev_b32 v40, 16, v73
    v_and_b32 v41, s62, v73
    v_fmac_f32 v14, v34, v40
    v_fmac_f32 v15, v34, v41
    v_lshlrev_b32 v40, 16, v74
    v_and_b32 v41, s62, v74
    v_fmac_f32 v16, v34, v40
    v_fmac_f32 v17, v34, v41
    v_lshlrev_b32 v40, 16, v75
    v_and_b32 v41, s62, v75
    v_fmac_f32 v18, v34, v40
    v_fmac_f32 v19, v34, v41
    s_waitcnt vmcnt(0)
    v_lshlrev_b32 v40, 16, v76
    v_and_b32 v41, s62, v76
    v_fmac_f32 v12, v35, v40
    v_fmac_f32 v13, v35, v41
    v_lshlrev_b32 v40, 16, v77
    v_and_b32 v41, s62, v77
    v_fmac_f32 v14, v35, v40
    v_fmac_f32 v15, v35, v41
    v_lshlrev_b32 v40, 16, v78
    v_and_b32 v41, s62, v78
    v_fmac_f32 v16, v35, v40
    v_fmac_f32 v17, v35, v41
    v_lshlrev_b32 v40, 16, v79
    v_and_b32 v41, s62, v79
    v_fmac_f32 v18, v35, v40
    v_fmac_f32 v19, v35, v41
    s_cmp_ge_u32 s3, 4
    s_cbranch_scc1 L_T_NOPRIO
    s_setprio 3
L_T_NOPRIO:
    v_mov_b32 v38, v37
    s_nop 1
    v_permlane32_swap_b32 v37, v38
    v_add_f32 v37, v37, v38
    v_mov_b32 v38, v37
    s_nop 1
    v_permlane16_swap_b32 v37, v38
    v_add_f32 v37, v37, v38
    v_permlane32_swap_b32 v12, v13
    v_permlane32_swap_b32 v14, v15
    v_permlane32_swap_b32 v16, v17
    v_permlane32_swap_b32 v18, v19
    v_add_f32 v12, v12, v13
    v_add_f32 v14, v14, v15
    v_add_f32 v16, v16, v17
    v_add_f32 v18, v18, v19
    v_permlane16_swap_b32 v12, v14
    s_nop 0
    v_permlane16_swap_b32 v16, v18
    v_add_f32 v12, v12, v14
    v_add_f32 v16, v16, v18
    ds_write2_b32 v7, v12, v16 offset0:0 offset1:4
    s_lshl_b32 s58, s3, 3
    v_mov_b32 v5, s58
    s_mov_b64 exec, 1
    ds_write_b64 v5, v[36:37] offset:4608
    s_mov_b64 exec, -1
    s_waitcnt lgkmcnt(0)
    s_barrier
    v_mov_b32 v5, 0
    ds_read_b32 v6, v5 offset:4692
    s_waitcnt lgkmcnt(0)
    v_readfirstlane_b32 s67, v6
    s_nop 0
    s_lshr_b32 s64, s67, 3
    s_and_b32 s65, s67, 7
    s_cmp_lt_u32 s67, 128
    s_cbranch_scc1 L_T_ROLE
    s_cmp_ge_u32 s3, 2
    s_cbranch_scc1 L_T_EXIT
    s_branch L_T_COMB
L_T_ROLE:
    s_cmp_lt_u32 s3, 4
    s_cbranch_scc1 L_T_NOPF0
    s_lshl_b32 s58, s64, 18
    s_lshl_b32 s59, s65, 7
    s_add_u32 s58, s58, s59
    s_lshl_b32 s59, s3, 15
    s_add_u32 s58, s58, s59
    v_lshrrev_b32 v5, 5, v1
    v_lshlrev_b32 v5, 14, v5
    v_and_b32 v6, 31, v1
    v_lshl_add_u32 v5, v6, 2, v5
    v_add_u32 v5, s58, v5
    s_mov_b32 s56, 0
    buffer_load_dword v48, v5, s[44:47], s56 offen offset:0 nt
    buffer_load_dword v49, v5, s[44:47], s56 offen offset:1024 nt
    buffer_load_dword v50, v5, s[44:47], s56 offen offset:2048 nt
    buffer_load_dword v51, v5, s[44:47], s56 offen offset:3072 nt
    s_mov_b32 s56, 4096
    buffer_load_dword v52, v5, s[44:47], s56 offen offset:0 nt
    buffer_load_dword v53, v5, s[44:47], s56 offen offset:1024 nt
    buffer_load_dword v54, v5, s[44:47], s56 offen offset:2048 nt
    buffer_load_dword v55, v5, s[44:47], s56 offen offset:3072 nt
    s_mov_b32 s56, 8192
    buffer_load_dword v56, v5, s[44:47], s56 offen offset:0 nt
    buffer_load_dword v57, v5, s[44:47], s56 offen offset:1024 nt
    buffer_load_dword v58, v5, s[44:47], s56 offen offset:2048 nt
    buffer_load_dword v59, v5, s[44:47], s56 offen offset:3072 nt
    s_mov_b32 s56, 12288
    buffer_load_dword v60, v5, s[44:47], s56 offen offset:0 nt
    buffer_load_dword v61, v5, s[44:47], s56 offen offset:1024 nt
    buffer_load_dword v62, v5, s[44:47], s56 offen offset:2048 nt
    buffer_load_dword v63, v5, s[44:47], s56 offen offset:3072 nt
    s_cmp_ge_u32 s67, 43
    s_cbranch_scc1 L_NOC_1
    s_mul_i32 s58, s3, 176128
    s_lshl_b32 s59, s67, 6
    s_add_u32 s58, s58, s59
    v_mul_u32_u24 v5, 44032, v2
    v_lshl_add_u32 v5, v3, 2, v5
    v_add_u32 v5, s58, v5
    s_mov_b32 s56, 0
    buffer_load_dword v64, v5, s[48:51], s56 offen nt
    s_mov_b32 s56, 2752
    buffer_load_dword v65, v5, s[48:51], s56 offen nt
    s_mov_b32 s56, 5504
    buffer_load_dword v66, v5, s[48:51], s56 offen nt
    s_mov_b32 s56, 8256
    buffer_load_dword v67, v5, s[48:51], s56 offen nt
    s_mov_b32 s56, 11008
    buffer_load_dword v68, v5, s[48:51], s56 offen nt
    s_mov_b32 s56, 13760
    buffer_load_dword v69, v5, s[48:51], s56 offen nt
    s_mov_b32 s56, 16512
    buffer_load_dword v70, v5, s[48:51], s56 offen nt
    s_mov_b32 s56, 19264
    buffer_load_dword v71, v5, s[48:51], s56 offen nt
    s_mov_b32 s56, 22016
    buffer_load_dword v72, v5, s[48:51], s56 offen nt
    s_mov_b32 s56, 24768
    buffer_load_dword v73, v5, s[48:51], s56 offen nt
    s_mov_b32 s56, 27520
    buffer_load_dword v74, v5, s[48:51], s56 offen nt
    s_mov_b32 s56, 30272
    buffer_load_dword v75, v5, s[48:51], s56 offen nt
    s_mov_b32 s56, 33024
    buffer_load_dword v76, v5, s[48:51], s56 offen nt
    s_mov_b32 s56, 35776
    buffer_load_dword v77, v5, s[48:51], s56 offen nt
    s_mov_b32 s56, 38528
    buffer_load_dword v78, v5, s[48:51], s56 offen nt
    s_mov_b32 s56, 41280
    buffer_load_dword v79, v5, s[48:51], s56 offen nt
    s_lshl_b32 s58, s67, 15
    s_lshl_b32 s59, s3, 7
    s_add_u32 s58, s58, s59
    v_lshrrev_b32 v5, 5, v1
    v_lshlrev_b32 v5, 14, v5
    v_and_b32 v6, 31, v1
    v_lshl_add_u32 v5, v6, 2, v5
    v_add_u32 v5, s58, v5
    s_mov_b32 s56, 0
    buffer_load_dword v80, v5, s[52:55], s56 offen offset:0 nt
    s_mov_b32 s56, 0
    buffer_load_dword v81, v5, s[52:55], s56 offen offset:1024 nt
    s_mov_b32 s56, 0
    buffer_load_dword v82, v5, s[52:55], s56 offen offset:2048 nt
    s_mov_b32 s56, 0
    buffer_load_dword v83, v5, s[52:55], s56 offen offset:3072 nt
    s_mov_b32 s56, 4096
    buffer_load_dword v84, v5, s[52:55], s56 offen offset:0 nt
    s_mov_b32 s56, 4096
    buffer_load_dword v85, v5, s[52:55], s56 offen offset:1024 nt
    s_mov_b32 s56, 4096
    buffer_load_dword v86, v5, s[52:55], s56 offen offset:2048 nt
    s_mov_b32 s56, 4096
    buffer_load_dword v87, v5, s[52:55], s56 offen offset:3072 nt
    s_mov_b32 s56, 8192
    buffer_load_dword v88, v5, s[52:55], s56 offen offset:0 nt
    s_mov_b32 s56, 8192
    buffer_load_dword v89, v5, s[52:55], s56 offen offset:1024 nt
    s_mov_b32 s56, 8192
    buffer_load_dword v90, v5, s[52:55], s56 offen offset:2048 nt
    s_mov_b32 s56, 8192
    buffer_load_dword v91, v5, s[52:55], s56 offen offset:3072 nt
    s_mov_b32 s56, 12288
    buffer_load_dword v92, v5, s[52:55], s56 offen offset:0 nt
    s_mov_b32 s56, 12288
    buffer_load_dword v93, v5, s[52:55], s56 offen offset:1024 nt
    s_mov_b32 s56, 12288
    buffer_load_dword v94, v5, s[52:55], s56 offen offset:2048 nt
    s_mov_b32 s56, 12288
    buffer_load_dword v95, v5, s[52:55], s56 offen offset:3072 nt
    v_and_b32 v6, 31, v1
    s_lshl_b32 s58, s67, 5
    v_add_u32 v6, s58, v6
    v_lshlrev_b32 v5, 1, v6
    global_load_ushort v162, v5, s[18:19]
    v_min_u32 v6, 511, v6
    v_lshlrev_b32 v5, 1, v6
    global_load_ushort v161, v5, s[22:23]
L_NOC_1:
    s_waitcnt vmcnt(0)
    v_lshlrev_b32 v96, 16, v48
    v_and_b32 v97, s62, v48
    v_lshlrev_b32 v98, 16, v49
    v_and_b32 v99, s62, v49
    v_lshlrev_b32 v100, 16, v50
    v_and_b32 v101, s62, v50
    v_lshlrev_b32 v102, 16, v51
    v_and_b32 v103, s62, v51
    v_lshlrev_b32 v104, 16, v52
    v_and_b32 v105, s62, v52
    v_lshlrev_b32 v106, 16, v53
    v_and_b32 v107, s62, v53
    v_lshlrev_b32 v108, 16, v54
    v_and_b32 v109, s62, v54
    v_lshlrev_b32 v110, 16, v55
    v_and_b32 v111, s62, v55
    v_lshlrev_b32 v112, 16, v56
    v_and_b32 v113, s62, v56
    v_lshlrev_b32 v114, 16, v57
    v_and_b32 v115, s62, v57
    v_lshlrev_b32 v116, 16, v58
    v_and_b32 v117, s62, v58
    v_lshlrev_b32 v118, 16, v59
    v_and_b32 v119, s62, v59
    v_lshlrev_b32 v120, 16, v60
    v_and_b32 v121, s62, v60
    v_lshlrev_b32 v122, 16, v61
    v_and_b32 v123, s62, v61
    v_lshlrev_b32 v124, 16, v62
    v_and_b32 v125, s62, v62
    v_lshlrev_b32 v126, 16, v63
    v_and_b32 v127, s62, v63
    s_cmp_ge_u32 s67, 43
    s_cbranch_scc1 L_NOU_2
    v_lshlrev_b32 v128, 16, v64
    v_and_b32 v129, s62, v64
    v_lshlrev_b32 v130, 16, v65
    v_and_b32 v131, s62, v65
    v_lshlrev_b32 v132, 16, v66
    v_and_b32 v133, s62, v66
    v_lshlrev_b32 v134, 16, v67
    v_and_b32 v135, s62, v67
    v_lshlrev_b32 v136, 16, v68
    v_and_b32 v137, s62, v68
    v_lshlrev_b32 v138, 16, v69
    v_and_b32 v139, s62, v69
    v_lshlrev_b32 v140, 16, v70
    v_and_b32 v141, s62, v70
    v_lshlrev_b32 v142, 16, v71
    v_and_b32 v143, s62, v71
    v_lshlrev_b32 v144, 16, v72
    v_and_b32 v145, s62, v72
    v_lshlrev_b32 v146, 16, v73
    v_and_b32 v147, s62, v73
    v_lshlrev_b32 v148, 16, v74
    v_and_b32 v149, s62, v74
    v_lshlrev_b32 v150, 16, v75
    v_and_b32 v151, s62, v75
    v_lshlrev_b32 v152, 16, v76
    v_and_b32 v153, s62, v76
    v_lshlrev_b32 v154, 16, v77
    v_and_b32 v155, s62, v77
    v_lshlrev_b32 v156, 16, v78
    v_and_b32 v157, s62, v78
    v_lshlrev_b32 v158, 16, v79
    v_and_b32 v159, s62, v79
    v_pk_add_f32 v[164:165], v[128:129], v[130:131]
    v_pk_add_f32 v[164:165], v[164:165], v[132:133]
    v_pk_add_f32 v[164:165], v[164:165], v[134:135]
    v_pk_add_f32 v[164:165], v[164:165], v[136:137]
    v_pk_add_f32 v[164:165], v[164:165], v[138:139]
    v_pk_add_f32 v[164:165], v[164:165], v[140:141]
    v_pk_add_f32 v[164:165], v[164:165], v[142:143]
    v_pk_add_f32 v[164:165], v[164:165], v[144:145]
    v_pk_add_f32 v[164:165], v[164:165], v[146:147]
    v_pk_add_f32 v[164:165], v[164:165], v[148:149]
    v_pk_add_f32 v[164:165], v[164:165], v[150:151]
    v_pk_add_f32 v[164:165], v[164:165], v[152:153]
    v_pk_add_f32 v[164:165], v[164:165], v[154:155]
    v_pk_add_f32 v[164:165], v[164:165], v[156:157]
    v_pk_add_f32 v[164:165], v[164:165], v[158:159]
L_NOU_2:
L_T_NOPF0:
    s_cmp_ge_u32 s3, 2
    s_cbranch_scc1 L_T_NOCOMB
L_T_COMB:
    v_mov_b32 v5, 0
    ds_read_b128 v[20:23], v5 offset:4608
    ds_read_b128 v[24:27], v5 offset:4624
    ds_read_b128 v[28:31], v5 offset:4640
    ds_read_b128 v[32:35], v5 offset:4656
    v_lshlrev_b32 v6, 2, v0
    ds_read_b32 v40, v6 offset:0
    ds_read_b32 v41, v6 offset:512
    ds_read_b32 v42, v6 offset:1024
    ds_read_b32 v43, v6 offset:1536
    ds_read_b32 v44, v6 offset:2048
    ds_read_b32 v45, v6 offset:2560
    ds_read_b32 v46, v6 offset:3072
    ds_read_b32 v47, v6 offset:3584
    s_waitcnt lgkmcnt(0)
    v_max3_f32 v36, v20, v22, v24
    v_max3_f32 v36, v36, v26, v28
    v_max3_f32 v36, v36, v30, v32
    v_max_f32 v36, v36, v34
    v_mul_f32 v37, s57, v36
    v_fma_f32 v20, v20, s57, -v37
    v_fma_f32 v22, v22, s57, -v37
    v_fma_f32 v24, v24, s57, -v37
    v_fma_f32 v26, v26, s57, -v37
    v_fma_f32 v28, v28, s57, -v37
    v_fma_f32 v30, v30, s57, -v37
    v_fma_f32 v32, v32, s57, -v37
    v_fma_f32 v34, v34, s57, -v37
    v_exp_f32 v20, v20
    v_exp_f32 v22, v22
    v_exp_f32 v24, v24
    v_exp_f32 v26, v26
    v_exp_f32 v28, v28
    v_exp_f32 v30, v30
    v_exp_f32 v32, v32
    v_exp_f32 v34, v34
    v_mul_f32 v38, v20, v40
    v_mul_f32 v37, v20, v21
    v_fmac_f32 v38, v22, v41
    v_fmac_f32 v37, v22, v23
    v_fmac_f32 v38, v24, v42
    v_fmac_f32 v37, v24, v25
    v_fmac_f32 v38, v26, v43
    v_fmac_f32 v37, v26, v27
    v_fmac_f32 v38, v28, v44
    v_fmac_f32 v37, v28, v29
    v_fmac_f32 v38, v30, v45
    v_fmac_f32 v37, v30, v31
    v_fmac_f32 v38, v32, v46
    v_fmac_f32 v37, v32, v33
    v_fmac_f32 v38, v34, v47
    v_fmac_f32 v37, v34, v35
    v_min_u32 v38, 0xfffffffe, v38
    v_min_u32 v36, 0xfffffffe, v36
    v_min_u32 v37, 0xfffffffe, v37
    s_lshl_b32 s58, s30, 13
    s_add_u32 s58, s58, 131072
    s_lshl_b32 s59, s31, 9
    s_add_u32 s59, s58, s59
    v_add_u32 v5, s59, v6
    global_store_dword v5, v38, s[28:29] sc0 sc1
    s_lshl_b32 s59, s31, 3
    s_add_u32 s58, s58, s59
    v_mov_b32 v5, s58
    v_add_u32 v5, 4096, v5
    v_cmp_eq_u32 vcc, 0, v0
    s_nop 0
    s_and_saveexec_b64 s[60:61], vcc
    s_cbranch_execz L_T_NOML
    global_store_dwordx2 v5, v[36:37], s[28:29] sc0 sc1
L_T_NOML:
    s_mov_b64 exec, -1
    s_cmp_ge_u32 s67, 128
    s_cbranch_scc1 L_T_EXIT
L_T_NOCOMB:
    s_cmp_ge_u32 s3, 4
    s_cbranch_scc1 L_T_NOHOP1
    s_lshl_b32 s58, s64, 18
    s_lshl_b32 s59, s65, 7
    s_add_u32 s58, s58, s59
    s_lshl_b32 s59, s3, 15
    s_add_u32 s58, s58, s59
    v_lshrrev_b32 v5, 5, v1
    v_lshlrev_b32 v5, 14, v5
    v_and_b32 v6, 31, v1
    v_lshl_add_u32 v5, v6, 2, v5
    v_add_u32 v5, s58, v5
    s_mov_b32 s56, 0
    buffer_load_dword v48, v5, s[44:47], s56 offen offset:0 nt
    buffer_load_dword v49, v5, s[44:47], s56 offen offset:1024 nt
    buffer_load_dword v50, v5, s[44:47], s56 offen offset:2048 nt
    buffer_load_dword v51, v5, s[44:47], s56 offen offset:3072 nt
    s_mov_b32 s56, 4096
    buffer_load_dword v52, v5, s[44:47], s56 offen offset:0 nt
    buffer_load_dword v53, v5, s[44:47], s56 offen offset:1024 nt
    buffer_load_dword v54, v5, s[44:47], s56 offen offset:2048 nt
    buffer_load_dword v55, v5, s[44:47], s56 offen offset:3072 nt
    s_mov_b32 s56, 8192
    buffer_load_dword v56, v5, s[44:47], s56 offen offset:0 nt
    buffer_load_dword v57, v5, s[44:47], s56 offen offset:1024 nt
    buffer_load_dword v58, v5, s[44:47], s56 offen offset:2048 nt
    buffer_load_dword v59, v5, s[44:47], s56 offen offset:3072 nt
    s_mov_b32 s56, 12288
    buffer_load_dword v60, v5, s[44:47], s56 offen offset:0 nt
    buffer_load_dword v61, v5, s[44:47], s56 offen offset:1024 nt
    buffer_load_dword v62, v5, s[44:47], s56 offen offset:2048 nt
    buffer_load_dword v63, v5, s[44:47], s56 offen offset:3072 nt
    s_cmp_ge_u32 s67, 43
    s_cbranch_scc1 L_NOC_3
    s_mul_i32 s58, s3, 176128
    s_lshl_b32 s59, s67, 6
    s_add_u32 s58, s58, s59
    v_mul_u32_u24 v5, 44032, v2
    v_lshl_add_u32 v5, v3, 2, v5
    v_add_u32 v5, s58, v5
    s_mov_b32 s56, 0
    buffer_load_dword v64, v5, s[48:51], s56 offen nt
    s_mov_b32 s56, 2752
    buffer_load_dword v65, v5, s[48:51], s56 offen nt
    s_mov_b32 s56, 5504
    buffer_load_dword v66, v5, s[48:51], s56 offen nt
    s_mov_b32 s56, 8256
    buffer_load_dword v67, v5, s[48:51], s56 offen nt
    s_mov_b32 s56, 11008
    buffer_load_dword v68, v5, s[48:51], s56 offen nt
    s_mov_b32 s56, 13760
    buffer_load_dword v69, v5, s[48:51], s56 offen nt
    s_mov_b32 s56, 16512
    buffer_load_dword v70, v5, s[48:51], s56 offen nt
    s_mov_b32 s56, 19264
    buffer_load_dword v71, v5, s[48:51], s56 offen nt
    s_mov_b32 s56, 22016
    buffer_load_dword v72, v5, s[48:51], s56 offen nt
    s_mov_b32 s56, 24768
    buffer_load_dword v73, v5, s[48:51], s56 offen nt
    s_mov_b32 s56, 27520
    buffer_load_dword v74, v5, s[48:51], s56 offen nt
    s_mov_b32 s56, 30272
    buffer_load_dword v75, v5, s[48:51], s56 offen nt
    s_mov_b32 s56, 33024
    buffer_load_dword v76, v5, s[48:51], s56 offen nt
    s_mov_b32 s56, 35776
    buffer_load_dword v77, v5, s[48:51], s56 offen nt
    s_mov_b32 s56, 38528
    buffer_load_dword v78, v5, s[48:51], s56 offen nt
    s_mov_b32 s56, 41280
    buffer_load_dword v79, v5, s[48:51], s56 offen nt
    s_lshl_b32 s58, s67, 15
    s_lshl_b32 s59, s3, 7
    s_add_u32 s58, s58, s59
    v_lshrrev_b32 v5, 5, v1
    v_lshlrev_b32 v5, 14, v5
    v_and_b32 v6, 31, v1
    v_lshl_add_u32 v5, v6, 2, v5
    v_add_u32 v5, s58, v5
    s_mov_b32 s56, 0
    buffer_load_dword v80, v5, s[52:55], s56 offen offset:0 nt
    s_mov_b32 s56, 0
    buffer_load_dword v81, v5, s[52:55], s56 offen offset:1024 nt
    s_mov_b32 s56, 0
    buffer_load_dword v82, v5, s[52:55], s56 offen offset:2048 nt
    s_mov_b32 s56, 0
    buffer_load_dword v83, v5, s[52:55], s56 offen offset:3072 nt
    s_mov_b32 s56, 4096
    buffer_load_dword v84, v5, s[52:55], s56 offen offset:0 nt
    s_mov_b32 s56, 4096
    buffer_load_dword v85, v5, s[52:55], s56 offen offset:1024 nt
    s_mov_b32 s56, 4096
    buffer_load_dword v86, v5, s[52:55], s56 offen offset:2048 nt
    s_mov_b32 s56, 4096
    buffer_load_dword v87, v5, s[52:55], s56 offen offset:3072 nt
    s_mov_b32 s56, 8192
    buffer_load_dword v88, v5, s[52:55], s56 offen offset:0 nt
    s_mov_b32 s56, 8192
    buffer_load_dword v89, v5, s[52:55], s56 offen offset:1024 nt
    s_mov_b32 s56, 8192
    buffer_load_dword v90, v5, s[52:55], s56 offen offset:2048 nt
    s_mov_b32 s56, 8192
    buffer_load_dword v91, v5, s[52:55], s56 offen offset:3072 nt
    s_mov_b32 s56, 12288
    buffer_load_dword v92, v5, s[52:55], s56 offen offset:0 nt
    s_mov_b32 s56, 12288
    buffer_load_dword v93, v5, s[52:55], s56 offen offset:1024 nt
    s_mov_b32 s56, 12288
    buffer_load_dword v94, v5, s[52:55], s56 offen offset:2048 nt
    s_mov_b32 s56, 12288
    buffer_load_dword v95, v5, s[52:55], s56 offen offset:3072 nt
    v_and_b32 v6, 31, v1
    s_lshl_b32 s58, s67, 5
    v_add_u32 v6, s58, v6
    v_lshlrev_b32 v5, 1, v6
    global_load_ushort v162, v5, s[18:19]
    v_min_u32 v6, 511, v6
    v_lshlrev_b32 v5, 1, v6
    global_load_ushort v161, v5, s[22:23]
L_NOC_3:
    v_lshrrev_b32 v5, 7, v0
    v_and_b32 v6, 127, v0
    s_lshl_b32 s58, s64, 14
    s_add_u32 s58, s58, 131072
    v_lshlrev_b32 v5, 13, v5
    v_add_u32 v5, s58, v5
    v_lshl_add_u32 v6, v6, 2, v5
    v_add_u32 v5, 4096, v5
    s_waitcnt vmcnt(0)
    v_lshlrev_b32 v96, 16, v48
    v_and_b32 v97, s62, v48
    v_lshlrev_b32 v98, 16, v49
    v_and_b32 v99, s62, v49
    v_lshlrev_b32 v100, 16, v50
    v_and_b32 v101, s62, v50
    v_lshlrev_b32 v102, 16, v51
    v_and_b32 v103, s62, v51
    v_lshlrev_b32 v104, 16, v52
    v_and_b32 v105, s62, v52
    v_lshlrev_b32 v106, 16, v53
    v_and_b32 v107, s62, v53
    v_lshlrev_b32 v108, 16, v54
    v_and_b32 v109, s62, v54
    v_lshlrev_b32 v110, 16, v55
    v_and_b32 v111, s62, v55
    v_lshlrev_b32 v112, 16, v56
    v_and_b32 v113, s62, v56
    v_lshlrev_b32 v114, 16, v57
    v_and_b32 v115, s62, v57
    v_lshlrev_b32 v116, 16, v58
    v_and_b32 v117, s62, v58
    v_lshlrev_b32 v118, 16, v59
    v_and_b32 v119, s62, v59
    v_lshlrev_b32 v120, 16, v60
    v_and_b32 v121, s62, v60
    v_lshlrev_b32 v122, 16, v61
    v_and_b32 v123, s62, v61
    v_lshlrev_b32 v124, 16, v62
    v_and_b32 v125, s62, v62
    v_lshlrev_b32 v126, 16, v63
    v_and_b32 v127, s62, v63
    s_cmp_ge_u32 s67, 43
    s_cbranch_scc1 L_NOU_4
    v_lshlrev_b32 v128, 16, v64
    v_and_b32 v129, s62, v64
    v_lshlrev_b32 v130, 16, v65
    v_and_b32 v131, s62, v65
    v_lshlrev_b32 v132, 16, v66
    v_and_b32 v133, s62, v66
    v_lshlrev_b32 v134, 16, v67
    v_and_b32 v135, s62, v67
    v_lshlrev_b32 v136, 16, v68
    v_and_b32 v137, s62, v68
    v_lshlrev_b32 v138, 16, v69
    v_and_b32 v139, s62, v69
    v_lshlrev_b32 v140, 16, v70
    v_and_b32 v141, s62, v70
    v_lshlrev_b32 v142, 16, v71
    v_and_b32 v143, s62, v71
    v_lshlrev_b32 v144, 16, v72
    v_and_b32 v145, s62, v72
    v_lshlrev_b32 v146, 16, v73
    v_and_b32 v147, s62, v73
    v_lshlrev_b32 v148, 16, v74
    v_and_b32 v149, s62, v74
    v_lshlrev_b32 v150, 16, v75
    v_and_b32 v151, s62, v75
    v_lshlrev_b32 v152, 16, v76
    v_and_b32 v153, s62, v76
    v_lshlrev_b32 v154, 16, v77
    v_and_b32 v155, s62, v77
    v_lshlrev_b32 v156, 16, v78
    v_and_b32 v157, s62, v78
    v_lshlrev_b32 v158, 16, v79
    v_and_b32 v159, s62, v79
    v_pk_add_f32 v[164:165], v[128:129], v[130:131]
    v_pk_add_f32 v[164:165], v[164:165], v[132:133]
    v_pk_add_f32 v[164:165], v[164:165], v[134:135]
    v_pk_add_f32 v[164:165], v[164:165], v[136:137]
    v_pk_add_f32 v[164:165], v[164:165], v[138:139]
    v_pk_add_f32 v[164:165], v[164:165], v[140:141]
    v_pk_add_f32 v[164:165], v[164:165], v[142:143]
    v_pk_add_f32 v[164:165], v[164:165], v[144:145]
    v_pk_add_f32 v[164:165], v[164:165], v[146:147]
    v_pk_add_f32 v[164:165], v[164:165], v[148:149]
    v_pk_add_f32 v[164:165], v[164:165], v[150:151]
    v_pk_add_f32 v[164:165], v[164:165], v[152:153]
    v_pk_add_f32 v[164:165], v[164:165], v[154:155]
    v_pk_add_f32 v[164:165], v[164:165], v[156:157]
    v_pk_add_f32 v[164:165], v[164:165], v[158:159]
L_NOU_4:
    s_mov_b32 s63, 0
    global_load_dwordx4 v[20:23], v5, s[28:29] offset:0 sc0 sc1
    global_load_dwordx4 v[24:27], v5, s[28:29] offset:16 sc0 sc1
    global_load_dwordx4 v[28:31], v5, s[28:29] offset:32 sc0 sc1
    global_load_dwordx4 v[32:35], v5, s[28:29] offset:48 sc0 sc1
    s_sleep 5
L_HOP1A:
    global_load_dwordx4 v[48:51], v5, s[28:29] offset:0 sc0 sc1
    global_load_dwordx4 v[52:55], v5, s[28:29] offset:16 sc0 sc1
    global_load_dwordx4 v[56:59], v5, s[28:29] offset:32 sc0 sc1
    global_load_dwordx4 v[60:63], v5, s[28:29] offset:48 sc0 sc1
    s_waitcnt vmcnt(4)
    v_max3_u32 v44, v20, v21, v22
    v_max3_u32 v44, v44, v23, v24
    v_max3_u32 v44, v44, v25, v26
    v_max3_u32 v44, v44, v27, v28
    v_max3_u32 v44, v44, v29, v30
    v_max3_u32 v44, v44, v31, v32
    v_max3_u32 v44, v44, v33, v34
    v_max_u32 v44, v44, v35
    v_cmp_eq_u32 vcc, -1, v44
    s_cbranch_vccz L_HOP1A_d0
    global_load_dwordx4 v[20:23], v5, s[28:29] offset:0 sc0 sc1
    global_load_dwordx4 v[24:27], v5, s[28:29] offset:16 sc0 sc1
    global_load_dwordx4 v[28:31], v5, s[28:29] offset:32 sc0 sc1
    global_load_dwordx4 v[32:35], v5, s[28:29] offset:48 sc0 sc1
    s_waitcnt vmcnt(4)
    v_max3_u32 v44, v48, v49, v50
    v_max3_u32 v44, v44, v51, v52
    v_max3_u32 v44, v44, v53, v54
    v_max3_u32 v44, v44, v55, v56
    v_max3_u32 v44, v44, v57, v58
    v_max3_u32 v44, v44, v59, v60
    v_max3_u32 v44, v44, v61, v62
    v_max_u32 v44, v44, v63
    v_cmp_eq_u32 vcc, -1, v44
    s_cbranch_vccz L_HOP1A_d1
    s_add_u32 s63, s63, 1
    s_cmp_lt_u32 s63, 200000
    s_cbranch_scc1 L_HOP1A
L_HOP1A_d1:
    global_load_dword v36, v6, s[28:29] offset:0 sc0 sc1
    global_load_dword v37, v6, s[28:29] offset:512 sc0 sc1
    global_load_dword v38, v6, s[28:29] offset:1024 sc0 sc1
    global_load_dword v39, v6, s[28:29] offset:1536 sc0 sc1
    global_load_dword v40, v6, s[28:29] offset:2048 sc0 sc1
    global_load_dword v41, v6, s[28:29] offset:2560 sc0 sc1
    global_load_dword v42, v6, s[28:29] offset:3072 sc0 sc1
    global_load_dword v43, v6, s[28:29] offset:3584 sc0 sc1
    v_max3_f32 v44, v48, v50, v52
    v_max3_f32 v44, v44, v54, v56
    v_max3_f32 v44, v44, v58, v60
    v_max_f32 v44, v44, v62
    v_mul_f32 v45, s57, v44
    v_fma_f32 v12, v48, s57, -v45
    v_fma_f32 v13, v50, s57, -v45
    v_fma_f32 v14, v52, s57, -v45
    v_fma_f32 v15, v54, s57, -v45
    v_fma_f32 v16, v56, s57, -v45
    v_fma_f32 v17, v58, s57, -v45
    v_fma_f32 v18, v60, s57, -v45
    v_fma_f32 v19, v62, s57, -v45
    v_exp_f32 v12, v12
    v_exp_f32 v13, v13
    v_exp_f32 v14, v14
    v_exp_f32 v15, v15
    v_exp_f32 v16, v16
    v_exp_f32 v17, v17
    v_exp_f32 v18, v18
    v_exp_f32 v19, v19
    v_mul_f32 v45, v12, v49
    v_fmac_f32 v45, v13, v51
    v_fmac_f32 v45, v14, v53
    v_fmac_f32 v45, v15, v55
    v_fmac_f32 v45, v16, v57
    v_fmac_f32 v45, v17, v59
    v_fmac_f32 v45, v18, v61
    v_fmac_f32 v45, v19, v63
    v_rcp_f32 v45, v45
    s_branch L_HOP1A_end
L_HOP1A_d0:
    global_load_dword v36, v6, s[28:29] offset:0 sc0 sc1
    global_load_dword v37, v6, s[28:29] offset:512 sc0 sc1
    global_load_dword v38, v6, s[28:29] offset:1024 sc0 sc1
    global_load_dword v39, v6, s[28:29] offset:1536 sc0 sc1
    global_load_dword v40, v6, s[28:29] offset:2048 sc0 sc1
    global_load_dword v41, v6, s[28:29] offset:2560 sc0 sc1
    global_load_dword v42, v6, s[28:29] offset:3072 sc0 sc1
    global_load_dword v43, v6, s[28:29] offset:3584 sc0 sc1
    v_max3_f32 v44, v20, v22, v24
    v_max3_f32 v44, v44, v26, v28
    v_max3_f32 v44, v44, v30, v32
    v_max_f32 v44, v44, v34
    v_mul_f32 v45, s57, v44
    v_fma_f32 v12, v20, s57, -v45
    v_fma_f32 v13, v22, s57, -v45
    v_fma_f32 v14, v24, s57, -v45
    v_fma_f32 v15, v26, s57, -v45
    v_fma_f32 v16, v28, s57, -v45
    v_fma_f32 v17, v30, s57, -v45
    v_fma_f32 v18, v32, s57, -v45
    v_fma_f32 v19, v34, s57, -v45
    v_exp_f32 v12, v12
    v_exp_f32 v13, v13
    v_exp_f32 v14, v14
    v_exp_f32 v15, v15
    v_exp_f32 v16, v16
    v_exp_f32 v17, v17
    v_exp_f32 v18, v18
    v_exp_f32 v19, v19
    v_mul_f32 v45, v12, v21
    v_fmac_f32 v45, v13, v23
    v_fmac_f32 v45, v14, v25
    v_fmac_f32 v45, v15, v27
    v_fmac_f32 v45, v16, v29
    v_fmac_f32 v45, v17, v31
    v_fmac_f32 v45, v18, v33
    v_fmac_f32 v45, v19, v35
    v_rcp_f32 v45, v45
L_HOP1A_end:
    s_waitcnt vmcnt(0)
    v_max3_u32 v44, v36, v37, v38
    v_max3_u32 v44, v44, v39, v40
    v_max3_u32 v44, v44, v41, v42
    v_max_u32 v44, v44, v43
    v_cmp_eq_u32 vcc, -1, v44
    s_cbranch_vccz L_HOP1_ok
    s_mov_b32 s63, 0
L_HOP1:
    global_load_dword v36, v6, s[28:29] offset:0 sc0 sc1
    global_load_dword v37, v6, s[28:29] offset:512 sc0 sc1
    global_load_dword v38, v6, s[28:29] offset:1024 sc0 sc1
    global_load_dword v39, v6, s[28:29] offset:1536 sc0 sc1
    global_load_dword v40, v6, s[28:29] offset:2048 sc0 sc1
    global_load_dword v41, v6, s[28:29] offset:2560 sc0 sc1
    global_load_dword v42, v6, s[28:29] offset:3072 sc0 sc1
    global_load_dword v43, v6, s[28:29] offset:3584 sc0 sc1
    s_waitcnt vmcnt(0)
    v_max3_u32 v44, v36, v37, v38
    v_max3_u32 v44, v44, v39, v40
    v_max3_u32 v44, v44, v41, v42
    v_max_u32 v44, v44, v43
    v_cmp_eq_u32 vcc, -1, v44
    s_cbranch_vccz L_HOP1_done
    s_add_u32 s63, s63, 1
    s_cmp_lt_u32 s63, 200000
    s_cbranch_scc0 L_HOP1_done
    s_sleep 1
    s_branch L_HOP1
L_HOP1_done:
L_HOP1_ok:
    v_mul_f32 v46, v12, v36
    v_fmac_f32 v46, v13, v37
    v_fmac_f32 v46, v14, v38
    v_fmac_f32 v46, v15, v39
    v_fmac_f32 v46, v16, v40
    v_fmac_f32 v46, v17, v41
    v_fmac_f32 v46, v18, v42
    v_fmac_f32 v46, v19, v43
    v_mul_f32 v46, v46, v45
    v_lshlrev_b32 v5, 2, v0
    ds_write_b32 v5, v46 offset:5120
L_T_NOHOP1:
    s_waitcnt lgkmcnt(0)
    s_barrier
    v_lshrrev_b32 v5, 5, v1
    v_lshlrev_b32 v5, 6, v5
    s_lshl_b32 s58, s3, 7
    v_add_u32 v5, s58, v5
    ds_read_b128 v[20:23], v5 offset:5120
    ds_read_b128 v[24:27], v5 offset:5136
    ds_read_b128 v[28:31], v5 offset:5152
    ds_read_b128 v[32:35], v5 offset:5168
    s_waitcnt lgkmcnt(0)
    v_pk_mul_f32 v[12:13], v[96:97], v[20:21] op_sel_hi:[1,0]
    v_pk_fma_f32 v[12:13], v[98:99], v[20:21], v[12:13] op_sel:[0,1,0] op_sel_hi:[1,1,1]
    v_pk_fma_f32 v[12:13], v[100:101], v[22:23], v[12:13] op_sel_hi:[1,0,1]
    v_pk_fma_f32 v[12:13], v[102:103], v[22:23], v[12:13] op_sel:[0,1,0] op_sel_hi:[1,1,1]
    v_pk_fma_f32 v[12:13], v[104:105], v[24:25], v[12:13] op_sel_hi:[1,0,1]
    v_pk_fma_f32 v[12:13], v[106:107], v[24:25], v[12:13] op_sel:[0,1,0] op_sel_hi:[1,1,1]
    v_pk_fma_f32 v[12:13], v[108:109], v[26:27], v[12:13] op_sel_hi:[1,0,1]
    v_pk_fma_f32 v[12:13], v[110:111], v[26:27], v[12:13] op_sel:[0,1,0] op_sel_hi:[1,1,1]
    v_pk_fma_f32 v[12:13], v[112:113], v[28:29], v[12:13] op_sel_hi:[1,0,1]
    v_pk_fma_f32 v[12:13], v[114:115], v[28:29], v[12:13] op_sel:[0,1,0] op_sel_hi:[1,1,1]
    v_pk_fma_f32 v[12:13], v[116:117], v[30:31], v[12:13] op_sel_hi:[1,0,1]
    v_pk_fma_f32 v[12:13], v[118:119], v[30:31], v[12:13] op_sel:[0,1,0] op_sel_hi:[1,1,1]
    v_pk_fma_f32 v[12:13], v[120:121], v[32:33], v[12:13] op_sel_hi:[1,0,1]
    v_pk_fma_f32 v[12:13], v[122:123], v[32:33], v[12:13] op_sel:[0,1,0] op_sel_hi:[1,1,1]
    v_pk_fma_f32 v[12:13], v[124:125], v[34:35], v[12:13] op_sel_hi:[1,0,1]
    v_pk_fma_f32 v[12:13], v[126:127], v[34:35], v[12:13] op_sel:[0,1,0] op_sel_hi:[1,1,1]
    s_nop 1
    v_permlane32_swap_b32 v12, v13
    v_add_f32 v12, v12, v13
    v_and_b32 v5, 31, v1
    v_lshrrev_b32 v6, 5, v1
    v_lshl_add_u32 v5, v5, 1, v6
    v_lshlrev_b32 v5, 2, v5
    s_lshl_b32 s58, s3, 8
    v_add_u32 v5, s58, v5
    ds_write_b32 v5, v12 offset:6144
    s_waitcnt lgkmcnt(0)
    s_barrier
    s_cmp_lg_u32 s3, 0
    s_cbranch_scc1 L_T_BDONE
    v_lshlrev_b32 v5, 2, v1
    ds_read_b32 v12, v5 offset:6144
    ds_read_b32 v13, v5 offset:6400
    ds_read_b32 v14, v5 offset:6656
    ds_read_b32 v15, v5 offset:6912
    ds_read_b32 v16, v5 offset:7168
    ds_read_b32 v17, v5 offset:7424
    ds_read_b32 v18, v5 offset:7680
    ds_read_b32 v19, v5 offset:7936
    s_waitcnt lgkmcnt(0)
    v_add_f32 v12, v12, v13
    v_add_f32 v14, v14, v15
    v_add_f32 v16, v16, v17
    v_add_f32 v18, v18, v19
    v_add_f32 v12, v12, v14
    v_add_f32 v16, v16, v18
    v_add_f32 v12, v12, v16
    v_min_u32 v12, 0xfffffffe, v12
    s_lshl_b32 s58, s64, 11
    s_lshl_b32 s59, s65, 8
    s_add_u32 s58, s58, s59
    s_add_u32 s58, s58, 393216
    v_add_u32 v5, s58, v5
    global_store_dword v5, v12, s[28:29] sc0 sc1
L_T_BDONE:
    s_cmp_ge_u32 s67, 43
    s_cbranch_scc1 L_T_EXIT
    v_lshlrev_b32 v96, 16, v80
    v_and_b32 v97, s62, v80
    v_lshlrev_b32 v98, 16, v81
    v_and_b32 v99, s62, v81
    v_lshlrev_b32 v100, 16, v82
    v_and_b32 v101, s62, v82
    v_lshlrev_b32 v102, 16, v83
    v_and_b32 v103, s62, v83
    v_lshlrev_b32 v104, 16, v84
    v_and_b32 v105, s62, v84
    v_lshlrev_b32 v106, 16, v85
    v_and_b32 v107, s62, v85
    v_lshlrev_b32 v108, 16, v86
    v_and_b32 v109, s62, v86
    v_lshlrev_b32 v110, 16, v87
    v_and_b32 v111, s62, v87
    v_lshlrev_b32 v112, 16, v88
    v_and_b32 v113, s62, v88
    v_lshlrev_b32 v114, 16, v89
    v_and_b32 v115, s62, v89
    v_lshlrev_b32 v116, 16, v90
    v_and_b32 v117, s62, v90
    v_lshlrev_b32 v118, 16, v91
    v_and_b32 v119, s62, v91
    v_lshlrev_b32 v120, 16, v92
    v_and_b32 v121, s62, v92
    v_lshlrev_b32 v122, 16, v93
    v_and_b32 v123, s62, v93
    v_lshlrev_b32 v124, 16, v94
    v_and_b32 v125, s62, v94
    v_lshlrev_b32 v126, 16, v95
    v_and_b32 v127, s62, v95
    s_cmp_lt_u32 s3, 4
    s_cbranch_scc1 L_T_C_B7
    v_lshrrev_b32 v5, 7, v0
    v_and_b32 v5, 1, v5
    v_and_b32 v6, 127, v0
    v_lshlrev_b32 v5, 14, v5
    v_lshl_add_u32 v6, v6, 4, v5
    v_add_u32 v6, 393216, v6
    v_add_u32 v7, 4096, v6
    v_add_u32 v8, 8192, v6
    v_add_u32 v9, 12288, v6
    s_mov_b32 s63, 0
L_HOP2:
    global_load_dwordx4 v[12:15], v6, s[28:29] offset:0 sc0 sc1
    global_load_dwordx4 v[16:19], v6, s[28:29] offset:2048 sc0 sc1
    global_load_dwordx4 v[20:23], v7, s[28:29] offset:0 sc0 sc1
    global_load_dwordx4 v[24:27], v7, s[28:29] offset:2048 sc0 sc1
    global_load_dwordx4 v[28:31], v8, s[28:29] offset:0 sc0 sc1
    global_load_dwordx4 v[32:35], v8, s[28:29] offset:2048 sc0 sc1
    global_load_dwordx4 v[36:39], v9, s[28:29] offset:0 sc0 sc1
    global_load_dwordx4 v[40:43], v9, s[28:29] offset:2048 sc0 sc1
    s_waitcnt vmcnt(0)
    v_max3_u32 v44, v12, v13, v14
    v_max3_u32 v44, v44, v15, v16
    v_max3_u32 v44, v44, v17, v18
    v_max3_u32 v44, v44, v19, v20
    v_max3_u32 v44, v44, v21, v22
    v_max3_u32 v44, v44, v23, v24
    v_max3_u32 v44, v44, v25, v26
    v_max3_u32 v44, v44, v27, v28
    v_max3_u32 v44, v44, v29, v30
    v_max3_u32 v44, v44, v31, v32
    v_max3_u32 v44, v44, v33, v34
    v_max3_u32 v44, v44, v35, v36
    v_max3_u32 v44, v44, v37, v38
    v_max3_u32 v44, v44, v39, v40
    v_max3_u32 v44, v44, v41, v42
    v_max_u32 v44, v44, v43
    v_cmp_eq_u32 vcc, -1, v44
    s_cbranch_vccz L_HOP2_done
    s_add_u32 s63, s63, 1
    s_cmp_lt_u32 s63, 200000
    s_cbranch_scc0 L_HOP2_done
    s_sleep 1
    s_branch L_HOP2
L_HOP2_done:
    v_add_f32 v12, v12, v16
    v_add_f32 v20, v20, v24
    v_add_f32 v28, v28, v32
    v_add_f32 v36, v36, v40
    v_add_f32 v12, v12, v20
    v_add_f32 v28, v28, v36
    v_add_f32 v12, v12, v28
    v_add_f32 v13, v13, v17
    v_add_f32 v21, v21, v25
    v_add_f32 v29, v29, v33
    v_add_f32 v37, v37, v41
    v_add_f32 v13, v13, v21
    v_add_f32 v29, v29, v37
    v_add_f32 v13, v13, v29
    v_add_f32 v14, v14, v18
    v_add_f32 v22, v22, v26
    v_add_f32 v30, v30, v34
    v_add_f32 v38, v38, v42
    v_add_f32 v14, v14, v22
    v_add_f32 v30, v30, v38
    v_add_f32 v14, v14, v30
    v_add_f32 v15, v15, v19
    v_add_f32 v23, v23, v27
    v_add_f32 v31, v31, v35
    v_add_f32 v39, v39, v43
    v_add_f32 v15, v15, v23
    v_add_f32 v31, v31, v39
    v_add_f32 v15, v15, v31
    v_mov_b32 v48, v12
    v_mov_b32 v49, v13
    v_mov_b32 v50, v14
    v_mov_b32 v51, v15
    s_cmp_lg_u32 s67, 0
    s_cbranch_scc1 L_T_NOEP
    s_cmp_lg_u32 s3, 4
    s_cbranch_scc1 L_T_NOEP
    v_mov_b32 v5, 0
    ds_read_b64 v[20:21], v5 offset:4672
    v_mov_b32 v5, 786432
    s_waitcnt lgkmcnt(0)
    s_mov_b64 exec, 1
    global_store_dwordx2 v5, v[20:21], s[28:29] sc0 sc1
    s_mov_b64 exec, -1
L_T_NOEP:
    v_lshrrev_b32 v5, 7, v0
    v_and_b32 v5, 1, v5
    v_and_b32 v6, 127, v0
    v_lshlrev_b32 v6, 4, v6
    v_lshl_add_u32 v5, v5, 11, v6
    ds_write_b128 v5, v[48:51] offset:8192
L_T_C_B7:
    s_waitcnt lgkmcnt(0)
    s_barrier
    v_lshlrev_b32 v5, 2, v0
    ds_read_b32 v20, v5 offset:8192
    ds_read_b32 v21, v5 offset:10240
    v_lshlrev_b32 v160, 16, v160
    s_waitcnt lgkmcnt(0)
    v_add_f32 v20, v20, v21
    v_add_f32 v20, v160, v20
    ds_write_b32 v5, v20 offset:16384
    s_waitcnt vmcnt(0)
    s_waitcnt lgkmcnt(0)
    s_barrier
    v_lshlrev_b32 v5, 5, v1
    ds_read_b128 v[36:39], v5 offset:16384
    ds_read_b128 v[40:43], v5 offset:16400
    v_lshlrev_b32 v6, 6, v2
    s_lshl_b32 s58, s3, 8
    v_add_u32 v6, s58, v6
    ds_read_b128 v[20:23], v6 offset:16384
    ds_read_b128 v[24:27], v6 offset:16400
    ds_read_b128 v[28:31], v6 offset:16416
    ds_read_b128 v[32:35], v6 offset:16432
    s_waitcnt lgkmcnt(0)
    v_add_f32 v44, v36, v37
    v_pk_mul_f32 v[12:13], v[128:129], v[20:21] op_sel_hi:[1,0]
    v_add_f32 v45, v38, v39
    v_pk_fma_f32 v[12:13], v[130:131], v[20:21], v[12:13] op_sel:[0,1,0] op_sel_hi:[1,1,1]
    v_add_f32 v46, v40, v41
    v_pk_fma_f32 v[12:13], v[132:133], v[22:23], v[12:13] op_sel_hi:[1,0,1]
    v_add_f32 v47, v42, v43
    v_pk_fma_f32 v[12:13], v[134:135], v[22:23], v[12:13] op_sel:[0,1,0] op_sel_hi:[1,1,1]
    v_add_f32 v44, v44, v45
    v_pk_fma_f32 v[12:13], v[136:137], v[24:25], v[12:13] op_sel_hi:[1,0,1]
    v_add_f32 v46, v46, v47
    v_pk_fma_f32 v[12:13], v[138:139], v[24:25], v[12:13] op_sel:[0,1,0] op_sel_hi:[1,1,1]
    v_add_f32 v44, v44, v46
    v_pk_fma_f32 v[12:13], v[140:141], v[26:27], v[12:13] op_sel_hi:[1,0,1]
    s_nop 0
    v_add_f32 v44, v44, v44 row_ror:8 row_mask:0xf bank_mask:0xf
    v_pk_fma_f32 v[12:13], v[142:143], v[26:27], v[12:13] op_sel:[0,1,0] op_sel_hi:[1,1,1]
    s_nop 0
    v_add_f32 v44, v44, v44 row_ror:4 row_mask:0xf bank_mask:0xf
    v_pk_fma_f32 v[12:13], v[144:145], v[28:29], v[12:13] op_sel_hi:[1,0,1]
    s_nop 0
    v_add_f32 v44, v44, v44 row_ror:2 row_mask:0xf bank_mask:0xf
    v_pk_fma_f32 v[12:13], v[146:147], v[28:29], v[12:13] op_sel:[0,1,0] op_sel_hi:[1,1,1]
    s_nop 0
    v_add_f32 v44, v44, v44 row_ror:1 row_mask:0xf bank_mask:0xf
    v_pk_fma_f32 v[12:13], v[148:149], v[30:31], v[12:13] op_sel_hi:[1,0,1]
    v_mov_b32 v45, v44
    v_pk_fma_f32 v[12:13], v[150:151], v[30:31], v[12:13] op_sel:[0,1,0] op_sel_hi:[1,1,1]
    s_nop 0
    v_permlane32_swap_b32 v44, v45
    v_pk_fma_f32 v[12:13], v[152:153], v[32:33], v[12:13] op_sel_hi:[1,0,1]
    v_add_f32 v44, v44, v45
    v_pk_fma_f32 v[12:13], v[154:155], v[32:33], v[12:13] op_sel:[0,1,0] op_sel_hi:[1,1,1]
    v_mov_b32 v45, v44
    v_pk_fma_f32 v[12:13], v[156:157], v[34:35], v[12:13] op_sel_hi:[1,0,1]
    s_nop 0
    v_permlane16_swap_b32 v44, v45
    v_pk_fma_f32 v[12:13], v[158:159], v[34:35], v[12:13] op_sel:[0,1,0] op_sel_hi:[1,1,1]
    v_add_f32 v44, v44, v45
    v_mul_f32 v44, 0x3b000000, v44
    v_sub_f32 v36, v36, v44
    v_sub_f32 v37, v37, v44
    v_sub_f32 v38, v38, v44
    v_sub_f32 v39, v39, v44
    v_sub_f32 v40, v40, v44
    v_sub_f32 v41, v41, v44
    v_sub_f32 v42, v42, v44
    v_sub_f32 v43, v43, v44
    v_mul_f32 v45, v36, v36
    v_fmac_f32 v45, v37, v37
    v_fmac_f32 v45, v38, v38
    v_fmac_f32 v45, v39, v39
    v_fmac_f32 v45, v40, v40
    v_fmac_f32 v45, v41, v41
    v_fmac_f32 v45, v42, v42
    v_fmac_f32 v45, v43, v43
    s_nop 1
    v_add_f32 v45, v45, v45 row_ror:8 row_mask:0xf bank_mask:0xf
    s_nop 1
    v_add_f32 v45, v45, v45 row_ror:4 row_mask:0xf bank_mask:0xf
    s_nop 1
    v_add_f32 v45, v45, v45 row_ror:2 row_mask:0xf bank_mask:0xf
    s_nop 1
    v_add_f32 v45, v45, v45 row_ror:1 row_mask:0xf bank_mask:0xf
    v_mov_b32 v46, v45
    s_nop 1
    v_permlane32_swap_b32 v45, v46
    v_add_f32 v45, v45, v46
    v_mov_b32 v46, v45
    s_nop 1
    v_permlane16_swap_b32 v45, v46
    v_add_f32 v45, v45, v46
    v_mul_f32 v45, 0x3b000000, v45
    v_add_f32 v45, 0x3727c5ac, v45
    v_rsq_f32 v45, v45
    v_fma_f32 v12, -v44, v164, v12
    v_fma_f32 v13, -v44, v165, v13
    v_mul_f32 v12, v12, v45
    v_mul_f32 v13, v13, v45
    s_nop 1
    v_permlane32_swap_b32 v12, v13
    v_add_f32 v12, v12, v13
    v_mov_b32 v14, v12
    s_nop 1
    v_permlane16_swap_b32 v12, v14
    v_add_f32 v12, v12, v14
    v_lshrrev_b32 v5, 1, v2
    v_lshl_add_u32 v5, v3, 1, v5
    v_lshlrev_b32 v5, 2, v5
    s_lshl_b32 s58, s3, 7
    v_add_u32 v5, s58, v5
    ds_write_b32 v5, v12 offset:6144
    s_waitcnt lgkmcnt(0)
    s_barrier
    v_and_b32 v5, 31, v1
    v_lshlrev_b32 v5, 2, v5
    v_lshrrev_b32 v6, 5, v1
    v_lshl_add_u32 v6, v6, 9, v5
    ds_read_b32 v12, v6 offset:6144
    ds_read_b32 v13, v6 offset:6272
    ds_read_b32 v14, v6 offset:6400
    ds_read_b32 v15, v6 offset:6528
    s_waitcnt lgkmcnt(0)
    v_add_f32 v12, v12, v13
    v_add_f32 v14, v14, v15
    v_add_f32 v12, v12, v14
    v_mov_b32 v13, v12
    s_nop 1
    v_permlane32_swap_b32 v12, v13
    v_add_f32 v12, v12, v13
    v_lshlrev_b32 v162, 16, v162
    v_add_f32 v12, v12, v162
    v_max_f32 v12, 0, v12
    v_mul_f32 v12, v12, v12
    v_and_b32 v5, 31, v1
    v_lshlrev_b32 v5, 2, v5
    s_lshl_b32 s58, s3, 7
    v_add_u32 v5, s58, v5
    ds_write_b32 v5, v12 offset:18432
    v_lshrrev_b32 v6, 5, v1
    v_lshlrev_b32 v6, 6, v6
    v_add_u32 v6, s58, v6
    s_waitcnt lgkmcnt(0)
    ds_read_b128 v[20:23], v6 offset:18432
    ds_read_b128 v[24:27], v6 offset:18448
    ds_read_b128 v[28:31], v6 offset:18464
    ds_read_b128 v[32:35], v6 offset:18480
    s_waitcnt lgkmcnt(0)
    v_pk_mul_f32 v[12:13], v[96:97], v[20:21] op_sel_hi:[1,0]
    v_pk_fma_f32 v[12:13], v[98:99], v[20:21], v[12:13] op_sel:[0,1,0] op_sel_hi:[1,1,1]
    v_pk_fma_f32 v[12:13], v[100:101], v[22:23], v[12:13] op_sel_hi:[1,0,1]
    v_pk_fma_f32 v[12:13], v[102:103], v[22:23], v[12:13] op_sel:[0,1,0] op_sel_hi:[1,1,1]
    v_pk_fma_f32 v[12:13], v[104:105], v[24:25], v[12:13] op_sel_hi:[1,0,1]
    v_pk_fma_f32 v[12:13], v[106:107], v[24:25], v[12:13] op_sel:[0,1,0] op_sel_hi:[1,1,1]
    v_pk_fma_f32 v[12:13], v[108:109], v[26:27], v[12:13] op_sel_hi:[1,0,1]
    v_pk_fma_f32 v[12:13], v[110:111], v[26:27], v[12:13] op_sel:[0,1,0] op_sel_hi:[1,1,1]
    v_pk_fma_f32 v[12:13], v[112:113], v[28:29], v[12:13] op_sel_hi:[1,0,1]
    v_pk_fma_f32 v[12:13], v[114:115], v[28:29], v[12:13] op_sel:[0,1,0] op_sel_hi:[1,1,1]
    v_pk_fma_f32 v[12:13], v[116:117], v[30:31], v[12:13] op_sel_hi:[1,0,1]
    v_pk_fma_f32 v[12:13], v[118:119], v[30:31], v[12:13] op_sel:[0,1,0] op_sel_hi:[1,1,1]
    v_pk_fma_f32 v[12:13], v[120:121], v[32:33], v[12:13] op_sel_hi:[1,0,1]
    v_pk_fma_f32 v[12:13], v[122:123], v[32:33], v[12:13] op_sel:[0,1,0] op_sel_hi:[1,1,1]
    v_pk_fma_f32 v[12:13], v[124:125], v[34:35], v[12:13] op_sel_hi:[1,0,1]
    v_pk_fma_f32 v[12:13], v[126:127], v[34:35], v[12:13] op_sel:[0,1,0] op_sel_hi:[1,1,1]
    s_nop 1
    v_permlane32_swap_b32 v12, v13
    v_add_f32 v12, v12, v13
    v_min_u32 v12, 0xfffffffe, v12
    s_lshl_b32 s58, s67, 11
    s_lshl_b32 s59, s3, 8
    s_add_u32 s58, s58, s59
    s_add_u32 s58, s58, 425984
    v_and_b32 v5, 31, v1
    v_lshrrev_b32 v6, 5, v1
    v_lshl_add_u32 v5, v5, 1, v6
    v_lshl_add_u32 v5, v5, 2, s58
    global_store_dword v5, v12, s[28:29] sc0 sc1
    s_cmp_ge_u32 s67, 16
    s_cbranch_scc1 L_T_EXIT
    s_cmp_ge_u32 s3, 4
    s_cbranch_scc1 L_T_EXIT
    v_and_b32 v5, 31, v0
    v_lshrrev_b32 v6, 5, v0
    s_lshl_b32 s58, s67, 7
    s_add_u32 s58, s58, 425984
    v_lshlrev_b32 v7, 11, v6
    v_lshl_add_u32 v7, v5, 2, v7
    v_add_u32 v7, s58, v7
    v_add_u32 v8, 0x4000, v7
    v_add_u32 v9, 0x8000, v7
    v_add_u32 v10, 0xc000, v7
    v_add_u32 v11, 0x10000, v7
    v_add_u32 v16, 0x14000, v7
    v_mov_b32 v25, 0
    v_mov_b32 v31, 0
    v_cmp_gt_u32 s[60:61], 3, v6
    s_mov_b32 s63, 0
    global_load_dword v20, v7, s[28:29] sc0 sc1
    global_load_dword v21, v8, s[28:29] sc0 sc1
    global_load_dword v22, v9, s[28:29] sc0 sc1
    global_load_dword v23, v10, s[28:29] sc0 sc1
    global_load_dword v24, v11, s[28:29] sc0 sc1
    s_mov_b64 exec, s[60:61]
    s_cbranch_execz L_T_NO3_1
    global_load_dword v25, v16, s[28:29] sc0 sc1
L_T_NO3_1:
    s_mov_b64 exec, -1
    s_sleep 5
L_HOP3:
    global_load_dword v26, v7, s[28:29] sc0 sc1
    global_load_dword v27, v8, s[28:29] sc0 sc1
    global_load_dword v28, v9, s[28:29] sc0 sc1
    global_load_dword v29, v10, s[28:29] sc0 sc1
    global_load_dword v30, v11, s[28:29] sc0 sc1
    s_mov_b64 exec, s[60:61]
    s_cbranch_execz L_T_NO3_2
    global_load_dword v31, v16, s[28:29] sc0 sc1
L_T_NO3_2:
    s_mov_b64 exec, -1
    s_waitcnt vmcnt(5)
    v_max3_u32 v40, v20, v21, v22
    v_max3_u32 v40, v40, v23, v24
    v_max_u32 v40, v40, v25
    v_cmp_eq_u32 vcc, -1, v40
    s_cbranch_vccz L_HOP3_d0
    global_load_dword v20, v7, s[28:29] sc0 sc1
    global_load_dword v21, v8, s[28:29] sc0 sc1
    global_load_dword v22, v9, s[28:29] sc0 sc1
    global_load_dword v23, v10, s[28:29] sc0 sc1
    global_load_dword v24, v11, s[28:29] sc0 sc1
    s_mov_b64 exec, s[60:61]
    s_cbranch_execz L_T_NO3_3
    global_load_dword v25, v16, s[28:29] sc0 sc1
L_T_NO3_3:
    s_mov_b64 exec, -1
    s_waitcnt vmcnt(5)
    v_max3_u32 v40, v26, v27, v28
    v_max3_u32 v40, v40, v29, v30
    v_max_u32 v40, v40, v31
    v_cmp_eq_u32 vcc, -1, v40
    s_cbranch_vccz L_HOP3_d1
    s_add_u32 s63, s63, 1
    s_cmp_lt_u32 s63, 200000
    s_cbranch_scc1 L_HOP3
L_HOP3_d1:
    v_add_f32 v12, v26, v27
    v_add_f32 v13, v28, v29
    v_add_f32 v14, v30, v31
    v_add_f32 v12, v12, v13
    v_add_f32 v12, v12, v14
    s_branch L_HOP3_end
L_HOP3_d0:
    v_add_f32 v12, v20, v21
    v_add_f32 v13, v22, v23
    v_add_f32 v14, v24, v25
    v_add_f32 v12, v12, v13
    v_add_f32 v12, v12, v14
L_HOP3_end:
    v_mov_b32 v13, v12
    s_nop 1
    v_permlane32_swap_b32 v12, v13
    v_add_f32 v12, v12, v13
    v_and_b32 v5, 31, v1
    v_lshlrev_b32 v5, 2, v5
    s_lshl_b32 s58, s3, 7
    v_add_u32 v6, s58, v5
    ds_write_b32 v6, v12 offset:19456
    s_waitcnt lgkmcnt(0)
    s_barrier
    s_cmp_lg_u32 s3, 0
    s_cbranch_scc1 L_T_EXIT
    v_lshrrev_b32 v6, 5, v1
    v_lshl_add_u32 v6, v6, 8, v5
    ds_read_b32 v12, v6 offset:19456
    ds_read_b32 v13, v6 offset:19584
    s_lshl_b32 s58, s67, 7
    v_add_u32 v6, s58, v5
    ds_read_b32 v20, v6 offset:16384
    s_waitcnt lgkmcnt(0)
    v_add_f32 v12, v12, v13
    v_mov_b32 v13, v12
    s_nop 1
    v_permlane32_swap_b32 v12, v13
    v_add_f32 v12, v12, v13
    v_lshlrev_b32 v161, 16, v161
    v_add_f32 v12, v12, v161
    v_add_f32 v12, v20, v12
    v_cvt_pk_bf16_f32 v12, v12, v12
    v_lshrrev_b32 v6, 1, v6
    s_mov_b32 exec_hi, 0
    global_store_short v6, v12, s[24:25]
    s_mov_b32 exec_hi, -1
L_T_EXIT:
    s_endpgm
L_AGENT:
    s_setprio 3
    v_mov_b32 v5, 786432
    global_load_dwordx2 v[14:15], v5, s[28:29] sc0 sc1
    v_lshlrev_b32 v4, 4, v1
    s_cmp_lg_u32 s31, 0
    s_cbranch_scc1 L_AG_NOCLEAR
    v_mov_b32 v8, -1
    v_mov_b32 v9, -1
    v_mov_b32 v10, -1
    v_mov_b32 v11, -1
    s_lshl_b32 s58, s30, 12
    s_add_u32 s58, s58, 393216
    v_add_u32 v6, s58, v4
    global_store_dwordx4 v6, v[8:11], s[28:29] offset:0 sc0 sc1
    global_store_dwordx4 v6, v[8:11], s[28:29] offset:1024 sc0 sc1
    global_store_dwordx4 v6, v[8:11], s[28:29] offset:2048 sc0 sc1
    global_store_dwordx4 v6, v[8:11], s[28:29] offset:3072 sc0 sc1
    s_lshl_b32 s58, s30, 13
    s_add_u32 s58, s58, 131072
    v_add_u32 v5, s58, v4
    v_add_u32 v6, 4096, v5
    global_store_dwordx4 v5, v[8:11], s[28:29] offset:0 sc0 sc1
    global_store_dwordx4 v5, v[8:11], s[28:29] offset:1024 sc0 sc1
    global_store_dwordx4 v5, v[8:11], s[28:29] offset:2048 sc0 sc1
    global_store_dwordx4 v5, v[8:11], s[28:29] offset:3072 sc0 sc1
    s_mov_b64 exec, 0xf
    global_store_dwordx4 v6, v[8:11], s[28:29] sc0 sc1
    s_mov_b64 exec, -1
L_AG_NOCLEAR:
    s_nop 0
    v_mov_b32 v8, 0
    v_mov_b32 v9, 0
    v_mov_b32 v6, 0
    ds_write_b64 v6, v[8:9] offset:4680
    ds_write_b64 v6, v[8:9] offset:4688
    s_waitcnt lgkmcnt(0)
    s_barrier
    v_mov_b32 v37, 0
    s_mov_b32 s63, 0
L_AGCNT:
    ds_read_b32 v36, v37 offset:4680
    s_waitcnt lgkmcnt(0)
    v_readfirstlane_b32 s58, v36
    s_nop 0
    s_cmp_lt_u32 s58, 8
    s_cbranch_scc0 L_AGCNT_done
    s_add_u32 s63, s63, 1
    s_cmp_lt_u32 s63, 3200000
    s_cbranch_scc1 L_AGCNT
L_AGCNT_done:
    v_lshlrev_b32 v6, 3, v1
    ds_read_b64 v[16:17], v6 offset:0
    ds_read_b64 v[18:19], v6 offset:512
    ds_read_b64 v[20:21], v6 offset:1024
    ds_read_b64 v[22:23], v6 offset:1536
    ds_read_b64 v[24:25], v6 offset:2048
    ds_read_b64 v[26:27], v6 offset:2560
    ds_read_b64 v[28:29], v6 offset:3072
    ds_read_b64 v[30:31], v6 offset:3584
    s_waitcnt lgkmcnt(0)
    v_add_f32 v16, v16, v18
    v_add_f32 v20, v20, v22
    v_add_f32 v24, v24, v26
    v_add_f32 v28, v28, v30
    v_add_f32 v16, v16, v20
    v_add_f32 v24, v24, v28
    v_add_f32 v16, v16, v24
    v_add_f32 v17, v17, v19
    v_add_f32 v21, v21, v23
    v_add_f32 v25, v25, v27
    v_add_f32 v29, v29, v31
    v_add_f32 v17, v17, v21
    v_add_f32 v25, v25, v29
    v_add_f32 v17, v17, v25
    v_mov_b32 v8, v16
    v_mov_b32 v9, v17
    s_waitcnt vmcnt(0)
    v_add_co_u32 v10, vcc, 1, v14
    s_nop 1
    v_addc_co_u32 v11, vcc, 0, v15, vcc
    s_lshl_b32 s58, s2, 10
    s_add_u32 s58, s58, 524288
    v_add_u32 v5, s58, v4
    global_store_dwordx4 v5, v[8:11], s[28:29] sc0 sc1
    s_cmp_lg_u32 s31, 0
    s_cbranch_scc1 L_AG_NOFLAG
    v_mov_b32 v12, 1
    s_lshl_b32 s59, s30, 2
    v_mov_b32 v13, s59
    s_mov_b64 exec, 1
    global_store_dword v13, v12, s[26:27] sc0 sc1
    s_mov_b64 exec, -1
L_AG_NOFLAG:
    v_mov_b32 v6, 0
    ds_write_b64 v6, v[10:11] offset:4672
    s_lshl_b32 s58, s30, 13
    s_add_u32 s58, s58, 524288
    v_add_u32 v5, s58, v4
    v_add_u32 v6, 4096, v5
    v_lshlrev_b32 v7, 10, v1
    v_add_u32 v7, s58, v7
    s_mov_b64 exec, 0xff
    s_mov_b32 s63, 0
L_POLLQ1:
    global_load_dwordx4 v[16:19], v7, s[28:29] sc0 sc1
    s_waitcnt vmcnt(0)
    v_xor_b32 v48, v18, v10
    v_xor_b32 v49, v19, v11
    v_or_b32 v12, v48, v49
    v_cmp_ne_u32 vcc, 0, v12
    s_cbranch_vccz L_POLLQ1_done
    s_add_u32 s63, s63, 1
    s_cmp_lt_u32 s63, 200000
    s_cbranch_scc0 L_POLLQ1_done
    s_sleep 1
    s_branch L_POLLQ1
L_POLLQ1_done:
    s_mov_b64 exec, -1
    s_mov_b32 s63, 0
L_POLLQ:
    global_load_dwordx4 v[16:19], v5, s[28:29] offset:0 sc0 sc1
    global_load_dwordx4 v[20:23], v5, s[28:29] offset:1024 sc0 sc1
    global_load_dwordx4 v[24:27], v5, s[28:29] offset:2048 sc0 sc1
    global_load_dwordx4 v[28:31], v5, s[28:29] offset:3072 sc0 sc1
    global_load_dwordx4 v[32:35], v6, s[28:29] offset:0 sc0 sc1
    global_load_dwordx4 v[36:39], v6, s[28:29] offset:1024 sc0 sc1
    global_load_dwordx4 v[40:43], v6, s[28:29] offset:2048 sc0 sc1
    global_load_dwordx4 v[44:47], v6, s[28:29] offset:3072 sc0 sc1
    s_waitcnt vmcnt(0)
    v_xor_b32 v48, v18, v10
    v_xor_b32 v49, v19, v11
    v_xor_b32 v50, v22, v10
    v_xor_b32 v51, v23, v11
    v_xor_b32 v52, v26, v10
    v_xor_b32 v53, v27, v11
    v_xor_b32 v54, v30, v10
    v_xor_b32 v55, v31, v11
    v_xor_b32 v56, v34, v10
    v_xor_b32 v57, v35, v11
    v_xor_b32 v58, v38, v10
    v_xor_b32 v59, v39, v11
    v_xor_b32 v60, v42, v10
    v_xor_b32 v61, v43, v11
    v_xor_b32 v62, v46, v10
    v_xor_b32 v63, v47, v11
    v_or3_b32 v12, v48, v49, v50
    v_or3_b32 v12, v12, v51, v52
    v_or3_b32 v12, v12, v53, v54
    v_or3_b32 v12, v12, v55, v56
    v_or3_b32 v12, v12, v57, v58
    v_or3_b32 v12, v12, v59, v60
    v_or3_b32 v12, v12, v61, v62
    v_or_b32 v12, v12, v63
    v_cmp_ne_u32 vcc, 0, v12
    s_cbranch_vccz L_POLLQ_done
    s_add_u32 s63, s63, 1
    s_cmp_lt_u32 s63, 200000
    s_cbranch_scc0 L_POLLQ_done
    s_sleep 1
    s_branch L_POLLQ
L_POLLQ_done:
    v_add_f32 v16, v16, v20
    v_add_f32 v24, v24, v28
    v_add_f32 v32, v32, v36
    v_add_f32 v40, v40, v44
    v_add_f32 v16, v16, v24
    v_add_f32 v32, v32, v40
    v_add_f32 v16, v16, v32
    v_add_f32 v17, v17, v21
    v_add_f32 v25, v25, v29
    v_add_f32 v33, v33, v37
    v_add_f32 v41, v41, v45
    v_add_f32 v17, v17, v25
    v_add_f32 v33, v33, v41
    v_add_f32 v17, v17, v33
    v_cvt_pk_bf16_f32 v12, v16, v17
    v_lshlrev_b32 v4, 2, v1
    ds_write_b32 v4, v12 offset:4096
    s_waitcnt lgkmcnt(0)
    v_mov_b32 v12, 1
    v_mov_b32 v6, 0
    ds_write_b32 v6, v12 offset:4684
    v_lshlrev_b32 v5, 2, v1
    s_mov_b32 exec_hi, 0
    s_mov_b32 s63, 0
L_POLLB:
    global_load_dword v6, v5, s[26:27] sc0 sc1
    s_waitcnt vmcnt(0)
    v_cmp_eq_u32 vcc, 0, v6
    s_cbranch_vccz L_POLLB_done
    s_add_u32 s63, s63, 1
    s_cmp_lt_u32 s63, 200000
    s_cbranch_scc0 L_POLLB_done
    s_sleep 1
    s_branch L_POLLB
L_POLLB_done:
    s_mov_b32 exec_hi, -1
    v_mov_b32 v37, 0
    s_mov_b32 s63, 0
L_AGPV:
    ds_read_b32 v36, v37 offset:4688
    s_waitcnt lgkmcnt(0)
    v_readfirstlane_b32 s58, v36
    s_nop 0
    s_cmp_lt_u32 s58, 8
    s_cbranch_scc0 L_AGPV_done
    s_add_u32 s63, s63, 1
    s_cmp_lt_u32 s63, 3200000
    s_cbranch_scc1 L_AGPV
L_AGPV_done:
    v_mov_b32 v5, 160
    v_mov_b32 v6, 1
    s_mov_b64 exec, 1
    global_atomic_add v7, v5, v6, s[26:27] sc0 sc1
    s_waitcnt vmcnt(0)
    v_mov_b32 v5, 0
    ds_write_b32 v5, v7 offset:4692
    s_mov_b64 exec, -1
    s_waitcnt lgkmcnt(0)
    s_barrier
    s_endpgm
L_END:
    s_endpgm
.section .rodata,"a"
.p2align 6
.amdhsa_kernel sequential_preLN__sliding_block_cached__dense_activation_squared_relu__decode_kernel
  .amdhsa_next_free_vgpr 168
  .amdhsa_next_free_sgpr 102
  .amdhsa_accum_offset 168
  .amdhsa_group_segment_fixed_size 0
  .amdhsa_kernarg_size 104
  .amdhsa_user_sgpr_count 2
  .amdhsa_user_sgpr_kernarg_segment_ptr 1
  .amdhsa_system_sgpr_workgroup_id_x 1
.end_amdhsa_kernel
```
